```python
import torch

def _softmax(x, axis=-1):
    return torch.softmax(x, dim=axis)
def _gelu(x):
    return torch.nn.functional.gelu(x, approximate="tanh")
def _silu(x):
    return torch.nn.functional.silu(x)
def _sigmoid(x):
    return torch.sigmoid(x)
def _layernorm(x, axis=-1, eps=1e-5):
    m = x.mean(dim=axis, keepdim=True)
    v = x.var(dim=axis, keepdim=True, unbiased=False)
    return (x - m) / torch.sqrt(v + eps)
def _scatter_add(tgt, idx, src, axis=0):
    return tgt.clone().index_add_(axis, idx, src)
def _segment_sum(src, seg, n):
    out = torch.zeros((n,) + src.shape[1:], dtype=src.dtype)
    return out.index_add_(0, seg, src)
def _pad(x, pw):
    flat = tuple(v for pair in reversed(pw) for v in pair)
    return torch.nn.functional.pad(x, flat)

kernel_name = 'gather_scatter__cheap_equivariant_egnn__graph'

def setup_inputs():

    _w = (lambda a: (lambda t: t.to(torch.bfloat16) if t.is_floating_point() else t)(torch.as_tensor(a)))
    N, deg, D, De = 10000, 64, 64, max(0, 1)
    E = N * deg
    return {
        "h": _w((lambda *s: torch.randn(*s, dtype=torch.bfloat16) * 0.1)(N, D)),
        "pos": _w((lambda *s: torch.randn(*s, dtype=torch.bfloat16) * 0.8)(N, 3)),
        "e_attr": _w((lambda *s: torch.randn(*s, dtype=torch.bfloat16) * 0.8)(E, De)),
        "src": _w((lambda lo, hi, *s: torch.randint(lo, hi, s))(0, N, E).to(torch.int64)),
        "dst": _w((lambda lo, hi, *s: torch.randint(lo, hi, s))(0, N, E).to(torch.int64)),
        "w_e": _w(0.1 * (lambda *s: torch.randn(*s, dtype=torch.bfloat16) * 0.8)(2 * D + 1 + De, D)),
        "w_x": _w(0.1 * (lambda *s: torch.randn(*s, dtype=torch.bfloat16) * 0.1)(D, 1)),
        "w_h": _w(0.1 * (lambda *s: torch.randn(*s, dtype=torch.bfloat16) * 0.1)(2 * D, D)),
    }

def reference(h, pos, e_attr, src, dst, w_e, w_x, w_h):
    N, D = h.shape[0], h.shape[1]
    diff = pos[dst] - pos[src]
    dist2 = torch.sum(diff * diff, axis=-1, keepdims=True)
    e_in = torch.concatenate([h[dst], h[src], dist2, e_attr], axis=-1)
    m_ij = _silu(e_in @ w_e)
    coord_scale = m_ij @ w_x
    pos_new = pos + _segment_sum(diff * coord_scale, dst, N)
    m_i = _segment_sum(m_ij, dst, N)
    h_new = h + _silu(torch.concatenate([h, m_i], axis=-1) @ w_h)
    return h_new, pos_new
```

```asm
; @launch grid=(250,1,1) block=(512,1,1) lds=158288
.amdgcn_target "amdgcn-amd-amdhsa--gfx950"
.text
.globl gather_scatter__cheap_equivariant_egnn__graph_kernel
.p2align 8
.type gather_scatter__cheap_equivariant_egnn__graph_kernel,@function
gather_scatter__cheap_equivariant_egnn__graph_kernel:
    s_cmp_ge_u32 s2, 250
    s_cbranch_scc1 L_end
    s_load_dwordx16 s[8:23], s[0:1], 0
    v_lshlrev_b32 v6, 2, v0
    v_mov_b32 v4, 0
    ds_write_b32 v6, v4 offset:60416
    v_mov_b32 v4, 10000
    v_mov_b32 v5, 10000
    v_lshlrev_b32 v6, 3, v0
    v_add_u32 v6, 145104, v6
    ds_write_b64 v6, v[4:5] offset:0
    ds_write_b64 v6, v[4:5] offset:4096
    ds_write_b64 v6, v[4:5] offset:8192
    v_lshlrev_b32 v6, 2, v0
    v_add_u32 v6, 157392, v6
    v_cmp_gt_u32 vcc, 64, v0
    s_and_saveexec_b64 s[4:5], vcc
    ds_write_b32 v6, v4
    s_mov_b64 exec, s[4:5]
    v_and_b32 v1, 63, v0
    v_and_b32 v2, 31, v0
    v_bfe_u32 v3, v0, 5, 1
    v_lshrrev_b32 v4, 6, v0
    v_lshlrev_b32 v209, 4, v1
    v_readfirstlane_b32 s3, v4
    v_lshlrev_b32 v4, 4, v0
    v_lshlrev_b32 v5, 3, v0
    v_lshlrev_b32 v6, 2, v0
    v_add_u32 v6, 8192, v6
    v_lshlrev_b32 v7, 1, v0
    v_add_u32 v7, 4096, v7
    v_and_b32 v8, 7, v1
    v_lshrrev_b32 v9, 4, v1
    v_xor_b32 v8, v8, v9
    v_lshlrev_b32 v141, 4, v8
    v_xor_b32 v143, 64, v141
    v_mov_b32 v145, v141
    v_mov_b32 v147, v143
    s_sub_u32 s96, s3, 3
    s_lshl_b32 s97, s96, 3
    s_mul_i32 s98, s2, 40
    s_add_u32 s98, s98, s97
    v_lshrrev_b32 v47, 3, v1
    v_add_u32 v47, s98, v47
    v_lshlrev_b32 v47, 7, v47
    s_and_b32 s97, s96, 1
    s_lshl_b32 s97, s97, 6
    v_xor_b32 v9, s97, v141
    v_add_u32 v47, v47, v9
    s_lshl_b32 s96, s96, 10
    s_add_u32 s96, s96, 139984
    s_add_u32 s98, s3, 8
    s_lshl_b32 s98, s98, 10
    s_add_u32 s99, s98, 66176
    s_mul_i32 s6, s2, 10240
    s_mul_i32 s7, s2, 5120
    s_waitcnt lgkmcnt(0)
    s_mov_b32 s36, s18
    s_and_b32 s37, s19, 0xffff
    s_mov_b32 s38, 16640
    s_mov_b32 s39, 0x20000
    s_mov_b32 s44, s8
    s_and_b32 s45, s9, 0xffff
    s_mov_b32 s46, 1280000
    s_mov_b32 s47, 0x20000
    s_mov_b32 m0, s99
    s_nop 0
    buffer_load_dwordx4 v209, s[36:39], s98 offen lds
    s_cmp_lt_u32 s3, 3
    s_cbranch_scc1 L_nohrow
    s_mov_b32 s4, 0
    s_mov_b32 m0, s96
    s_nop 0
    buffer_load_dwordx4 v47, s[44:47], s4 offen lds
L_nohrow:
    s_add_u32 s16, s16, s6
    s_addc_u32 s17, s17, 0
    global_load_dwordx4 v[28:31], v4, s[16:17]
    global_load_dword v32, v6, s[16:17]
    s_add_u32 s14, s14, s6
    s_addc_u32 s15, s15, 0
    global_load_dwordx4 v[36:39], v4, s[14:15]
    global_load_dword v40, v6, s[14:15]
    s_add_u32 s12, s12, s7
    s_addc_u32 s13, s13, 0
    global_load_dwordx2 v[44:45], v5, s[12:13]
    global_load_short_d16_hi v46, v7, s[12:13]
    s_barrier
    s_load_dwordx4 s[24:27], s[0:1], 64
    s_load_dwordx2 s[28:29], s[0:1], 80
    s_mov_b32 s40, s22
    s_and_b32 s41, s23, 0xffff
    s_mov_b32 s42, 16384
    s_mov_b32 s43, 0x20000
    s_mov_b32 s32, s10
    s_and_b32 s33, s11, 0xffff
    s_mov_b32 s34, 60000
    s_mov_b32 s35, 0x20000
    s_lshl_b32 s4, s3, 10
    s_add_u32 s5, s4, 66176
    s_mov_b32 m0, s5
    s_nop 0
    buffer_load_dwordx4 v209, s[36:39], s4 offen lds
    s_add_u32 s4, s3, 0
    s_lshl_b32 s4, s4, 10
    s_add_u32 s5, s4, 83584
    s_mov_b32 m0, s5
    s_nop 0
    buffer_load_dwordx4 v209, s[40:43], s4 offen lds
    s_add_u32 s4, s3, 8
    s_lshl_b32 s4, s4, 10
    s_add_u32 s5, s4, 83584
    s_mov_b32 m0, s5
    s_nop 0
    buffer_load_dwordx4 v209, s[40:43], s4 offen lds
    s_cmp_lg_u32 s3, 0
    s_cbranch_scc1 L_nowe16
    s_mov_b32 s4, 16384
    s_mov_b32 s5, 82560
    s_mov_b32 m0, s5
    s_nop 0
    buffer_load_dwordx4 v209, s[36:39], s4 offen lds
L_nowe16:
    v_lshlrev_b32 v4, 1, v2
    global_load_short_d16_hi v166, v4, s[20:21]
    global_load_short_d16_hi v167, v4, s[20:21] offset:64
    v_and_b32 v4, 255, v0
    v_lshrrev_b32 v4, 1, v4
    v_min_u32 v4, 119, v4
    s_mul_i32 s4, s2, 240
    v_lshlrev_b32 v4, 1, v4
    v_add_u32 v4, s4, v4
    global_load_short_d16_hi v170, v4, s[10:11]
    v_mov_b32 v171, 1
    v_mov_b32 v92, 0
    v_mov_b32 v93, 0
    v_lshrrev_b32 v4, 1, v2
    v_and_b32 v4, 7, v4
    v_xor_b32 v4, v4, v3
    v_lshlrev_b32 v4, 4, v4
    v_lshlrev_b32 v5, 7, v2
    v_xor_b32 v6, 0, v4
    v_add_u32 v204, v5, v6
    v_xor_b32 v6, 32, v4
    v_add_u32 v205, v5, v6
    v_xor_b32 v6, 64, v4
    v_add_u32 v206, v5, v6
    v_xor_b32 v6, 96, v4
    v_add_u32 v207, v5, v6
    v_lshlrev_b32 v4, 3, v3
    v_bfe_u32 v5, v1, 2, 2
    v_add_u32 v4, v4, v5
    v_lshlrev_b32 v4, 7, v4
    v_bfe_u32 v5, v1, 4, 1
    v_lshlrev_b32 v5, 5, v5
    v_add_u32 v4, v4, v5
    v_and_b32 v5, 3, v1
    v_lshlrev_b32 v5, 3, v5
    v_add_u32 v208, v4, v5
    s_waitcnt lgkmcnt(0)
    s_add_u32 s6, s28, 6291456
    s_addc_u32 s7, s29, 0
    s_mov_b32 s48, s6
    s_and_b32 s49, s7, 0xffff
    s_or_b32 s49, s49, 8388608
    s_mov_b32 s50, 10001
    s_mov_b32 s51, 0x20000
    v_mov_b32 v4, 6029312
    global_load_dwordx2 v[134:135], v4, s[28:29]
    s_waitcnt vmcnt(7)
    s_mov_b32 s6, -160
    s_mov_b32 s7, 0xffff0000
    v_mul_u32_u24 v4, 52429, v28
    v_lshrrev_b32 v4, 21, v4
    v_lshlrev_b32 v48, 2, v4
    ds_add_rtn_u32 v70, v48, v171 offset:60992
    v_lshlrev_b32 v5, 2, v28
    v_mad_i32_i24 v61, v4, s6, v5
    v_mul_u32_u24 v4, 52429, v29
    v_lshrrev_b32 v4, 21, v4
    v_lshlrev_b32 v49, 2, v4
    ds_add_rtn_u32 v71, v49, v171 offset:60992
    v_lshlrev_b32 v5, 2, v29
    v_mad_i32_i24 v63, v4, s6, v5
    v_mul_u32_u24 v4, 52429, v30
    v_lshrrev_b32 v4, 21, v4
    v_lshlrev_b32 v50, 2, v4
    ds_add_rtn_u32 v72, v50, v171 offset:60992
    v_lshlrev_b32 v5, 2, v30
    v_mad_i32_i24 v65, v4, s6, v5
    v_mul_u32_u24 v4, 52429, v31
    v_lshrrev_b32 v4, 21, v4
    v_lshlrev_b32 v51, 2, v4
    ds_add_rtn_u32 v73, v51, v171 offset:60992
    v_lshlrev_b32 v5, 2, v31
    v_mad_i32_i24 v67, v4, s6, v5
    v_mul_u32_u24 v4, 52429, v32
    v_lshrrev_b32 v4, 21, v4
    v_lshlrev_b32 v52, 2, v4
    ds_add_rtn_u32 v74, v52, v171 offset:60992
    v_lshlrev_b32 v5, 2, v32
    v_mad_i32_i24 v69, v4, s6, v5
    v_lshl_or_b32 v60, v44, 16, v36
    v_and_or_b32 v62, v44, s7, v37
    v_lshl_or_b32 v64, v45, 16, v38
    v_and_or_b32 v66, v45, s7, v39
    v_and_or_b32 v68, v46, s7, v40
    s_waitcnt lgkmcnt(0)
    s_barrier
    s_cmp_ge_u32 s3, 4
    s_cbranch_scc1 L_scanx
    ds_read_b128 v[28:31], v209 offset:60992
    s_waitcnt lgkmcnt(0)
    v_add_u32 v32, v28, v29
    v_add_u32 v33, v32, v30
    v_add_u32 v34, v33, v31
    v_mov_b32 v35, v34
    s_nop 1
    v_add_u32_dpp v35, v35, v35 row_shr:1 row_mask:0xf bank_mask:0xf bound_ctrl:0
    s_nop 1
    v_add_u32_dpp v35, v35, v35 row_shr:2 row_mask:0xf bank_mask:0xf bound_ctrl:0
    s_nop 1
    v_add_u32_dpp v35, v35, v35 row_shr:4 row_mask:0xf bank_mask:0xf bound_ctrl:0
    s_nop 1
    v_add_u32_dpp v35, v35, v35 row_shr:8 row_mask:0xf bank_mask:0xf bound_ctrl:0
    s_nop 1
    v_add_u32_dpp v35, v35, v35 row_bcast:15 row_mask:0xa bank_mask:0xf
    s_nop 1
    v_add_u32_dpp v35, v35, v35 row_bcast:31 row_mask:0xc bank_mask:0xf
    v_sub_u32 v36, v35, v34
    v_add_u32 v37, v36, v28
    v_add_u32 v38, v36, v32
    v_add_u32 v39, v36, v33
    ds_write_b128 v209, v[36:39] offset:62016
    s_waitcnt lgkmcnt(0)
    ds_read_b32 v75, v48 offset:62016
    ds_read_b32 v76, v49 offset:62016
    ds_read_b32 v77, v50 offset:62016
    ds_read_b32 v78, v51 offset:62016
    ds_read_b32 v79, v52 offset:62016
    v_lshlrev_b32 v4, 3, v0
    v_and_b32 v4, 1023, v4
    ds_read_b64 v[32:33], v4 offset:60992
    ds_read_b64 v[34:35], v4 offset:62016
    s_waitcnt lgkmcnt(0)
    s_mov_b32 s6, 99968
    v_add_u32 v5, v75, v70
    v_lshl_add_u32 v5, v5, 3, s6
    ds_write_b64 v5, v[60:61]
    v_add_u32 v5, v76, v71
    v_lshl_add_u32 v5, v5, 3, s6
    ds_write_b64 v5, v[62:63]
    v_add_u32 v5, v77, v72
    v_lshl_add_u32 v5, v5, 3, s6
    ds_write_b64 v5, v[64:65]
    v_add_u32 v5, v78, v73
    v_lshl_add_u32 v5, v5, 3, s6
    ds_write_b64 v5, v[66:67]
    v_add_u32 v5, v79, v74
    v_lshl_add_u32 v5, v5, 3, s6
    ds_write_b64 v5, v[68:69]
    v_lshl_or_b32 v40, v32, 12, v34
    v_lshl_or_b32 v42, v33, 12, v35
    s_branch L_scandone
L_scanx:
    s_lshr_b32 s4, s3, 1
    s_and_b32 s4, s4, 1
    s_lshl_b32 s4, s4, 12
    s_add_u32 s4, s4, 139984
    v_add_u32 v4, s4, v204
    ds_read_b128 v[84:87], v4
    v_add_u32 v4, s4, v205
    ds_read_b128 v[88:91], v4
    v_add_u32 v4, s4, v206
    ds_read_b128 v[92:95], v4
    v_add_u32 v4, s4, v207
    ds_read_b128 v[96:99], v4
    s_and_b32 s4, s3, 1
    s_lshl_b32 s4, s4, 6
    s_add_u32 s4, s4, 74368
    v_add_u32 v4, s4, v208
    ds_read_b64_tr_b16 v[100:101], v4 offset:0
    ds_read_b64_tr_b16 v[102:103], v4 offset:512
    ds_read_b64_tr_b16 v[104:105], v4 offset:2048
    ds_read_b64_tr_b16 v[106:107], v4 offset:2560
    ds_read_b64_tr_b16 v[108:109], v4 offset:4096
    ds_read_b64_tr_b16 v[110:111], v4 offset:4608
    ds_read_b64_tr_b16 v[112:113], v4 offset:6144
    ds_read_b64_tr_b16 v[114:115], v4 offset:6656
    ds_read_b128 v[28:31], v209 offset:60992
    s_waitcnt lgkmcnt(0)
    v_mfma_f32_32x32x16_bf16 v[116:131], v[100:103], v[84:87], 0
    v_mfma_f32_32x32x16_bf16 v[116:131], v[104:107], v[88:91], v[116:131]
    v_mfma_f32_32x32x16_bf16 v[116:131], v[108:111], v[92:95], v[116:131]
    v_mfma_f32_32x32x16_bf16 v[116:131], v[112:115], v[96:99], v[116:131]
    v_add_u32 v32, v28, v29
    v_add_u32 v33, v32, v30
    v_add_u32 v34, v33, v31
    v_mov_b32 v35, v34
    s_nop 1
    v_add_u32_dpp v35, v35, v35 row_shr:1 row_mask:0xf bank_mask:0xf bound_ctrl:0
    s_nop 1
    v_add_u32_dpp v35, v35, v35 row_shr:2 row_mask:0xf bank_mask:0xf bound_ctrl:0
    s_nop 1
    v_add_u32_dpp v35, v35, v35 row_shr:4 row_mask:0xf bank_mask:0xf bound_ctrl:0
    s_nop 1
    v_add_u32_dpp v35, v35, v35 row_shr:8 row_mask:0xf bank_mask:0xf bound_ctrl:0
    s_nop 1
    v_add_u32_dpp v35, v35, v35 row_bcast:15 row_mask:0xa bank_mask:0xf
    s_nop 1
    v_add_u32_dpp v35, v35, v35 row_bcast:31 row_mask:0xc bank_mask:0xf
    v_sub_u32 v36, v35, v34
    v_add_u32 v37, v36, v28
    v_add_u32 v38, v36, v32
    v_add_u32 v39, v36, v33
    ds_write_b128 v209, v[36:39] offset:62016
    s_waitcnt lgkmcnt(0)
    ds_read_b32 v75, v48 offset:62016
    ds_read_b32 v76, v49 offset:62016
    ds_read_b32 v77, v50 offset:62016
    ds_read_b32 v78, v51 offset:62016
    ds_read_b32 v79, v52 offset:62016
    s_mov_b32 s5, 0xbfb8aa3b
    v_mul_f32 v116, s5, v116
    v_mul_f32 v117, s5, v117
    v_mul_f32 v118, s5, v118
    v_mul_f32 v119, s5, v119
    v_mul_f32 v120, s5, v120
    v_mul_f32 v121, s5, v121
    v_mul_f32 v122, s5, v122
    v_mul_f32 v123, s5, v123
    v_mul_f32 v124, s5, v124
    v_mul_f32 v125, s5, v125
    v_mul_f32 v126, s5, v126
    v_mul_f32 v127, s5, v127
    v_mul_f32 v128, s5, v128
    v_mul_f32 v129, s5, v129
    v_mul_f32 v130, s5, v130
    v_mul_f32 v131, s5, v131
    v_cvt_pk_bf16_f32 v84, v116, v117
    v_cvt_pk_bf16_f32 v85, v118, v119
    v_cvt_pk_bf16_f32 v86, v120, v121
    v_cvt_pk_bf16_f32 v87, v122, v123
    v_cvt_pk_bf16_f32 v88, v124, v125
    v_cvt_pk_bf16_f32 v89, v126, v127
    v_cvt_pk_bf16_f32 v90, v128, v129
    v_cvt_pk_bf16_f32 v91, v130, v131
    s_waitcnt lgkmcnt(0)
    s_mov_b32 s6, 99968
    v_add_u32 v5, v75, v70
    v_lshl_add_u32 v5, v5, 3, s6
    ds_write_b64 v5, v[60:61]
    v_add_u32 v5, v76, v71
    v_lshl_add_u32 v5, v5, 3, s6
    ds_write_b64 v5, v[62:63]
    v_add_u32 v5, v77, v72
    v_lshl_add_u32 v5, v5, 3, s6
    ds_write_b64 v5, v[64:65]
    v_add_u32 v5, v78, v73
    v_lshl_add_u32 v5, v5, 3, s6
    ds_write_b64 v5, v[66:67]
    v_add_u32 v5, v79, v74
    v_lshl_add_u32 v5, v5, 3, s6
    ds_write_b64 v5, v[68:69]
    s_sub_u32 s4, s3, 4
    s_mul_i32 s4, s4, 2560
    s_cmp_eq_u32 s3, 7
    s_cselect_b32 s4, 5760, s4
    s_add_u32 s4, s4, 120448
    v_mul_u32_u24 v4, 80, v2
    v_lshlrev_b32 v5, 4, v3
    v_add3_u32 v4, v4, v5, s4
    v_permlane32_swap_b32 v84, v86
    v_permlane32_swap_b32 v85, v87
    v_permlane32_swap_b32 v88, v90
    v_permlane32_swap_b32 v89, v91
    s_cmp_ge_u32 s3, 6
    s_cselect_b32 s6, 8, 32
    v_cmp_gt_u32 vcc, s6, v2
    s_and_saveexec_b64 s[96:97], vcc
    ds_write_b128 v4, v[84:87]
    ds_write_b128 v4, v[88:91] offset:32
    s_mov_b64 exec, s[96:97]
    v_lshrrev_b32 v5, 2, v1
    v_and_b32 v6, 3, v1
    v_lshlrev_b32 v6, 4, v6
    v_mul_u32_u24 v7, 80, v5
    v_add3_u32 v92, v7, v6, s4
    s_lshr_b32 s4, s3, 1
    s_and_b32 s4, s4, 1
    s_lshl_b32 s5, s4, 5
    s_mul_i32 s6, s2, 40
    s_add_u32 s5, s5, s6
    s_lshl_b32 s5, s5, 7
    s_and_b32 s6, s3, 1
    s_lshl_b32 s6, s6, 6
    s_add_u32 s5, s5, s6
    s_add_u32 s5, s5, 6291456
    v_lshlrev_b32 v7, 7, v5
    v_add3_u32 v93, v7, v6, s5
L_scandone:
    s_waitcnt vmcnt(0) lgkmcnt(0)
    v_readfirstlane_b32 s100, v134
    v_readfirstlane_b32 s101, v135
    s_barrier
    s_add_u32 s100, s100, 1
    s_addc_u32 s101, s101, 0
    s_mov_b32 s30, s100
    s_lshl_b32 s31, s101, 24
    s_cmp_ge_u32 s3, 4
    s_cbranch_scc1 L_bpost
    v_lshlrev_b32 v4, 4, v0
    v_add_u32 v5, 99968, v4
    ds_read_b128 v[44:47], v5 offset:0
    ds_read_b128 v[48:51], v5 offset:4096
    ds_read_b128 v[52:55], v5 offset:8192
    ds_read_b128 v[56:59], v5 offset:12288
    ds_read_b128 v[60:63], v5 offset:16384
    s_mul_i32 s6, s2, 20480
    v_add_u32 v6, s6, v4
    s_waitcnt lgkmcnt(4)
    global_store_dwordx4 v6, v[44:47], s[28:29] sc1
    v_add_u32 v6, 4096, v6
    s_waitcnt lgkmcnt(3)
    global_store_dwordx4 v6, v[48:51], s[28:29] sc1
    v_add_u32 v6, 4096, v6
    s_waitcnt lgkmcnt(2)
    global_store_dwordx4 v6, v[52:55], s[28:29] sc1
    v_add_u32 v6, 4096, v6
    s_waitcnt lgkmcnt(1)
    global_store_dwordx4 v6, v[56:59], s[28:29] sc1
    v_add_u32 v6, 4096, v6
    s_waitcnt lgkmcnt(0)
    global_store_dwordx4 v6, v[60:63], s[28:29] sc1
    s_or_b32 s4, s2, s3
    s_cmp_lg_u32 s4, 0
    s_cbranch_scc1 L_co2
    v_mov_b32 v64, 0
    v_mov_b32 v65, 0
    v_mov_b32 v66, 0
    v_mov_b32 v67, 0
    v_add_u32 v7, 7571456, v4
    v_cmp_gt_u32 vcc, 8, v1
    s_and_saveexec_b64 s[96:97], vcc
    global_store_dwordx4 v7, v[64:67], s[28:29] sc1
    s_mov_b64 exec, s[96:97]
    s_branch L_co2
L_bpost:
    ds_read_b128 v[96:99], v92
    ds_read_b128 v[100:103], v92 offset:1280
    v_add_u32 v4, 2048, v93
    s_cmp_ge_u32 s3, 6
    s_cbranch_scc0 L_bfull
    s_mov_b64 exec, 0xffffffff
    s_waitcnt lgkmcnt(0)
    global_store_dwordx4 v93, v[96:99], s[28:29] sc1
    s_mov_b64 exec, -1
    s_branch L_co2
L_bfull:
    s_waitcnt lgkmcnt(1)
    global_store_dwordx4 v93, v[96:99], s[28:29] sc1
    s_waitcnt lgkmcnt(0)
    global_store_dwordx4 v4, v[100:103], s[28:29] sc1
L_co2:
    v_lshlrev_b32 v4, 3, v3
    v_sub_u32 v4, v2, v4
    v_and_b32 v5, 1, v2
    v_lshlrev_b32 v5, 4, v5
    v_mov_b32 v6, 0x3f80
    v_lshlrev_b32 v5, v5, v6
    v_ashrrev_i32 v4, 1, v4
    v_cmp_eq_u32 s[64:65], 0, v4
    v_cmp_eq_u32 s[66:67], 1, v4
    v_cmp_eq_u32 s[68:69], 2, v4
    v_cmp_eq_u32 s[70:71], 3, v4
    s_nop 0
    v_cndmask_b32_e64 v8, 0, v5, s[64:65]
    v_cndmask_b32_e64 v9, 0, v5, s[66:67]
    v_cndmask_b32_e64 v10, 0, v5, s[68:69]
    v_cndmask_b32_e64 v11, 0, v5, s[70:71]
    v_subrev_u32 v4, 8, v4
    v_cmp_eq_u32 s[64:65], 0, v4
    v_cmp_eq_u32 s[66:67], 1, v4
    v_cmp_eq_u32 s[68:69], 2, v4
    v_cmp_eq_u32 s[70:71], 3, v4
    s_nop 0
    v_cndmask_b32_e64 v12, 0, v5, s[64:65]
    v_cndmask_b32_e64 v13, 0, v5, s[66:67]
    v_cndmask_b32_e64 v14, 0, v5, s[68:69]
    v_cndmask_b32_e64 v15, 0, v5, s[70:71]
    v_lshrrev_b32 v4, 4, v2
    v_lshlrev_b32 v4, 1, v4
    v_bfe_u32 v5, v2, 2, 1
    v_add_u32 v4, v4, v5
    v_add_u32 v6, 2, v3
    v_mov_b32 v7, 0x3f803f80
    v_cmp_eq_u32 vcc, v4, v3
    v_cmp_eq_u32 s[96:97], v4, v6
    s_nop 1
    v_cndmask_b32_e64 v16, 0, v7, vcc
    v_cndmask_b32_e64 v17, 0, v7, s[96:97]
    v_lshlrev_b32 v4, 1, v2
    v_add_u32 v4, 82560, v4
    ds_read_u16_d16_hi v136, v4
    ds_read_u16_d16_hi v137, v4 offset:64
    ds_read_u16_d16_hi v138, v4 offset:128
    ds_read_u16_d16_hi v139, v4 offset:192
    s_mov_b32 s4, 0xbfb8aa3b
    s_mov_b32 s5, 0xffff0000
    v_cmp_eq_u32 s[96:97], 0, v3
    s_mov_b32 s6, 0xbf317218
    v_mul_f32 v166, s6, v166
    v_mul_f32 v167, s6, v167
    s_lshl_b32 s57, s3, 12
    s_add_u32 s57, s57, 96976
    v_add_u32 v148, s57, v204
    v_add_u32 v149, s57, v205
    v_add_u32 v150, s57, v206
    v_add_u32 v151, s57, v207
    v_lshlrev_b32 v4, 2, v2
    v_add_u32 v165, 129744, v4
    s_mov_b32 s52, 1.0
    s_mov_b32 s53, 1.0
    v_bfe_u32 v4, v1, 5, 1
    v_lshlrev_b32 v4, 3, v4
    v_bfe_u32 v5, v1, 4, 1
    v_lshlrev_b32 v5, 1, v5
    v_bfe_u32 v6, v1, 3, 1
    v_add3_u32 v4, v4, v5, v6
    v_lshlrev_b32 v168, 2, v4
    v_and_b32 v4, 0x13, v2
    v_and_b32 v5, 4, v2
    v_lshlrev_b32 v5, 1, v5
    v_and_b32 v6, 8, v2
    v_lshrrev_b32 v6, 1, v6
    v_or3_b32 v169, v4, v5, v6
    v_and_b32 v4, 3, v2
    v_mul_u32_u24 v4, 6160, v4
    v_lshlrev_b32 v5, 4, v3
    v_add_u32 v4, v4, v5
    v_lshrrev_b32 v5, 2, v2
    v_lshlrev_b32 v5, 18, v5
    v_sub_u32 v4, v4, v5
    v_add_u32 v210, 66176, v4
    v_mov_b32 v212, 0
    v_mov_b32 v213, 0
    v_mov_b32 v214, 0
    v_mov_b32 v215, 0
    v_mov_b32 v216, 0
    v_mov_b32 v217, 0
    v_mov_b32 v218, 0
    v_mov_b32 v219, 0
    v_mov_b32 v220, 0
    v_mov_b32 v221, 0
    v_mov_b32 v222, 0
    v_mov_b32 v223, 0
    v_mov_b32 v224, 0
    v_mov_b32 v225, 0
    v_mov_b32 v226, 0
    v_mov_b32 v227, 0
    v_mov_b32 v228, 0
    v_mov_b32 v229, 0
    v_mov_b32 v230, 0
    v_mov_b32 v231, 0
    v_mov_b32 v232, 0
    v_mov_b32 v233, 0
    v_mov_b32 v234, 0
    v_mov_b32 v235, 0
    v_mov_b32 v236, 0
    v_mov_b32 v237, 0
    v_mov_b32 v238, 0
    v_mov_b32 v239, 0
    v_mov_b32 v240, 0
    v_mov_b32 v241, 0
    v_mov_b32 v242, 0
    v_mov_b32 v243, 0
    s_waitcnt lgkmcnt(0)
    v_mul_f32 v136, s4, v136
    v_cvt_pk_bf16_f32 v4, v136, v136
    v_and_b32 v4, s5, v4
    v_sub_f32 v5, v136, v4
    v_cvt_pk_bf16_f32 v5, v5, v5
    v_and_b32 v5, s5, v5
    v_cndmask_b32_e64 v4, v5, v4, s[96:97]
    v_lshrrev_b32 v23, 16, v4
    v_mul_f32 v137, s4, v137
    v_cvt_pk_bf16_f32 v4, v137, v137
    v_and_b32 v4, s5, v4
    v_sub_f32 v5, v137, v4
    v_cvt_pk_bf16_f32 v5, v5, v5
    v_and_b32 v5, s5, v5
    v_cndmask_b32_e64 v4, v5, v4, s[96:97]
    v_lshrrev_b32 v27, 16, v4
    v_mul_f32 v138, s4, v138
    v_cvt_pk_bf16_f32 v4, v138, v138
    v_and_b32 v4, s5, v4
    v_sub_f32 v5, v138, v4
    v_cvt_pk_bf16_f32 v5, v5, v5
    v_and_b32 v5, s5, v5
    v_cndmask_b32_e64 v4, v5, v4, s[96:97]
    v_mov_b32 v22, v4
    v_mul_f32 v139, s4, v139
    v_cvt_pk_bf16_f32 v4, v139, v139
    v_and_b32 v4, s5, v4
    v_sub_f32 v5, v139, v4
    v_cvt_pk_bf16_f32 v5, v5, v5
    v_and_b32 v5, s5, v5
    v_cndmask_b32_e64 v4, v5, v4, s[96:97]
    v_mov_b32 v26, v4
    s_waitcnt vmcnt(0)
    s_barrier
    s_cmp_ge_u32 s3, 2
    s_cbranch_scc1 L_pubdone
    s_lshl_b32 s6, s2, 11
    s_add_u32 s6, s6, 5242880
    s_add_u32 s4, s28, s6
    s_addc_u32 s5, s29, 0
    v_lshlrev_b32 v4, 4, v0
    v_or_b32 v40, s31, v40
    v_mov_b32 v41, s30
    v_or_b32 v42, s31, v42
    v_mov_b32 v43, s30
    global_store_dwordx4 v4, v[40:43], s[4:5] sc1
L_pubdone:
    s_add_u32 s4, s3, 0
    s_lshl_b32 s4, s4, 10
    s_mov_b32 m0, s4
    s_nop 0
    buffer_load_dwordx4 v209, s[32:35], s4 offen lds
    s_add_u32 s4, s3, 8
    s_lshl_b32 s4, s4, 10
    s_mov_b32 m0, s4
    s_nop 0
    buffer_load_dwordx4 v209, s[32:35], s4 offen lds
    s_add_u32 s4, s3, 16
    s_lshl_b32 s4, s4, 10
    s_mov_b32 m0, s4
    s_nop 0
    buffer_load_dwordx4 v209, s[32:35], s4 offen lds
    s_add_u32 s4, s3, 24
    s_lshl_b32 s4, s4, 10
    s_mov_b32 m0, s4
    s_nop 0
    buffer_load_dwordx4 v209, s[32:35], s4 offen lds
    s_add_u32 s4, s3, 32
    s_lshl_b32 s4, s4, 10
    s_mov_b32 m0, s4
    s_nop 0
    buffer_load_dwordx4 v209, s[32:35], s4 offen lds
    s_add_u32 s4, s3, 40
    s_lshl_b32 s4, s4, 10
    s_mov_b32 m0, s4
    s_nop 0
    buffer_load_dwordx4 v209, s[32:35], s4 offen lds
    s_add_u32 s4, s3, 48
    s_lshl_b32 s4, s4, 10
    s_mov_b32 m0, s4
    s_nop 0
    buffer_load_dwordx4 v209, s[32:35], s4 offen lds
    s_add_u32 s4, s3, 56
    s_cmp_ge_u32 s4, 59
    s_cbranch_scc1 L_posdone
    s_lshl_b32 s4, s4, 10
    s_mov_b32 m0, s4
    s_nop 0
    buffer_load_dwordx4 v209, s[32:35], s4 offen lds
L_posdone:
    s_cmp_ge_u32 s3, 4
    s_cbranch_scc1 L_p3b
    s_lshr_b32 s4, s3, 1
    s_and_b32 s4, s4, 1
    s_lshl_b32 s4, s4, 12
    s_add_u32 s4, s4, 139984
    v_add_u32 v4, s4, v204
    ds_read_b128 v[44:47], v4
    v_add_u32 v4, s4, v205
    ds_read_b128 v[48:51], v4
    v_add_u32 v4, s4, v206
    ds_read_b128 v[52:55], v4
    v_add_u32 v4, s4, v207
    ds_read_b128 v[56:59], v4
    s_and_b32 s4, s3, 1
    s_lshl_b32 s4, s4, 6
    s_add_u32 s4, s4, 66176
    v_add_u32 v4, s4, v208
    ds_read_b64_tr_b16 v[60:61], v4 offset:0
    ds_read_b64_tr_b16 v[62:63], v4 offset:512
    ds_read_b64_tr_b16 v[64:65], v4 offset:2048
    ds_read_b64_tr_b16 v[66:67], v4 offset:2560
    ds_read_b64_tr_b16 v[68:69], v4 offset:4096
    ds_read_b64_tr_b16 v[70:71], v4 offset:4608
    ds_read_b64_tr_b16 v[72:73], v4 offset:6144
    ds_read_b64_tr_b16 v[74:75], v4 offset:6656
    s_and_b32 s4, s3, 1
    s_lshl_b32 s4, s4, 6
    s_add_u32 s4, s4, 83584
    v_add_u32 v4, s4, v208
    ds_read_b64_tr_b16 v[92:93], v4 offset:0
    ds_read_b64_tr_b16 v[94:95], v4 offset:512
    ds_read_b64_tr_b16 v[96:97], v4 offset:2048
    ds_read_b64_tr_b16 v[98:99], v4 offset:2560
    ds_read_b64_tr_b16 v[100:101], v4 offset:4096
    ds_read_b64_tr_b16 v[102:103], v4 offset:4608
    ds_read_b64_tr_b16 v[104:105], v4 offset:6144
    ds_read_b64_tr_b16 v[106:107], v4 offset:6656
    s_and_b32 s4, s3, 1
    s_lshl_b32 s4, s4, 6
    s_add_u32 s4, s4, 91776
    v_add_u32 v4, s4, v208
    ds_read_b64_tr_b16 v[188:189], v4 offset:0
    ds_read_b64_tr_b16 v[190:191], v4 offset:512
    ds_read_b64_tr_b16 v[192:193], v4 offset:2048
    ds_read_b64_tr_b16 v[194:195], v4 offset:2560
    ds_read_b64_tr_b16 v[196:197], v4 offset:4096
    ds_read_b64_tr_b16 v[198:199], v4 offset:4608
    ds_read_b64_tr_b16 v[200:201], v4 offset:6144
    ds_read_b64_tr_b16 v[202:203], v4 offset:6656
    s_waitcnt lgkmcnt(8)
    v_mfma_f32_32x32x16_bf16 v[76:91], v[44:47], v[60:63], 0
    v_mfma_f32_32x32x16_bf16 v[76:91], v[48:51], v[64:67], v[76:91]
    v_mfma_f32_32x32x16_bf16 v[76:91], v[52:55], v[68:71], v[76:91]
    v_mfma_f32_32x32x16_bf16 v[76:91], v[56:59], v[72:75], v[76:91]
    s_waitcnt lgkmcnt(0)
    v_mfma_f32_32x32x16_bf16 v[172:187], v[92:95], v[44:47], 0
    v_mfma_f32_32x32x16_bf16 v[172:187], v[96:99], v[48:51], v[172:187]
    v_mfma_f32_32x32x16_bf16 v[172:187], v[100:103], v[52:55], v[172:187]
    v_mfma_f32_32x32x16_bf16 v[172:187], v[104:107], v[56:59], v[172:187]
    s_lshr_b32 s4, s3, 1
    s_lshl_b32 s5, s4, 13
    s_and_b32 s6, s3, 1
    s_lshl_b32 s6, s6, 7
    s_add_u32 s5, s5, s6
    v_lshlrev_b32 v4, 10, v3
    v_add3_u32 v4, v4, v165, s5
    s_mov_b32 s6, 0xbfb8aa3b
    s_mov_b32 s7, 0xffff0000
    s_nop 3
    v_mul_f32 v5, s6, v76
    v_cvt_pk_bf16_f32 v6, v5, v5
    v_and_b32 v6, s7, v6
    v_sub_f32 v5, v5, v6
    v_cvt_pk_bf16_f32 v6, v6, v5
    ds_write_b32 v4, v6 offset:0
    v_mul_f32 v5, s6, v77
    v_cvt_pk_bf16_f32 v6, v5, v5
    v_and_b32 v6, s7, v6
    v_sub_f32 v5, v5, v6
    v_cvt_pk_bf16_f32 v6, v6, v5
    ds_write_b32 v4, v6 offset:256
    v_mul_f32 v5, s6, v78
    v_cvt_pk_bf16_f32 v6, v5, v5
    v_and_b32 v6, s7, v6
    v_sub_f32 v5, v5, v6
    v_cvt_pk_bf16_f32 v6, v6, v5
    ds_write_b32 v4, v6 offset:512
    v_mul_f32 v5, s6, v79
    v_cvt_pk_bf16_f32 v6, v5, v5
    v_and_b32 v6, s7, v6
    v_sub_f32 v5, v5, v6
    v_cvt_pk_bf16_f32 v6, v6, v5
    ds_write_b32 v4, v6 offset:768
    s_cmp_lg_u32 s4, 0
    s_cbranch_scc1 L_p3done
    v_mul_f32 v5, s6, v80
    v_cvt_pk_bf16_f32 v6, v5, v5
    v_and_b32 v6, s7, v6
    v_sub_f32 v5, v5, v6
    v_cvt_pk_bf16_f32 v6, v6, v5
    ds_write_b32 v4, v6 offset:2048
    v_mul_f32 v5, s6, v81
    v_cvt_pk_bf16_f32 v6, v5, v5
    v_and_b32 v6, s7, v6
    v_sub_f32 v5, v5, v6
    v_cvt_pk_bf16_f32 v6, v6, v5
    ds_write_b32 v4, v6 offset:2304
    v_mul_f32 v5, s6, v82
    v_cvt_pk_bf16_f32 v6, v5, v5
    v_and_b32 v6, s7, v6
    v_sub_f32 v5, v5, v6
    v_cvt_pk_bf16_f32 v6, v6, v5
    ds_write_b32 v4, v6 offset:2560
    v_mul_f32 v5, s6, v83
    v_cvt_pk_bf16_f32 v6, v5, v5
    v_and_b32 v6, s7, v6
    v_sub_f32 v5, v5, v6
    v_cvt_pk_bf16_f32 v6, v6, v5
    ds_write_b32 v4, v6 offset:2816
    v_mul_f32 v5, s6, v84
    v_cvt_pk_bf16_f32 v6, v5, v5
    v_and_b32 v6, s7, v6
    v_sub_f32 v5, v5, v6
    v_cvt_pk_bf16_f32 v6, v6, v5
    ds_write_b32 v4, v6 offset:4096
    v_mul_f32 v5, s6, v85
    v_cvt_pk_bf16_f32 v6, v5, v5
    v_and_b32 v6, s7, v6
    v_sub_f32 v5, v5, v6
    v_cvt_pk_bf16_f32 v6, v6, v5
    ds_write_b32 v4, v6 offset:4352
    v_mul_f32 v5, s6, v86
    v_cvt_pk_bf16_f32 v6, v5, v5
    v_and_b32 v6, s7, v6
    v_sub_f32 v5, v5, v6
    v_cvt_pk_bf16_f32 v6, v6, v5
    ds_write_b32 v4, v6 offset:4608
    v_mul_f32 v5, s6, v87
    v_cvt_pk_bf16_f32 v6, v5, v5
    v_and_b32 v6, s7, v6
    v_sub_f32 v5, v5, v6
    v_cvt_pk_bf16_f32 v6, v6, v5
    ds_write_b32 v4, v6 offset:4864
    v_mul_f32 v5, s6, v88
    v_cvt_pk_bf16_f32 v6, v5, v5
    v_and_b32 v6, s7, v6
    v_sub_f32 v5, v5, v6
    v_cvt_pk_bf16_f32 v6, v6, v5
    ds_write_b32 v4, v6 offset:6144
    v_mul_f32 v5, s6, v89
    v_cvt_pk_bf16_f32 v6, v5, v5
    v_and_b32 v6, s7, v6
    v_sub_f32 v5, v5, v6
    v_cvt_pk_bf16_f32 v6, v6, v5
    ds_write_b32 v4, v6 offset:6400
    v_mul_f32 v5, s6, v90
    v_cvt_pk_bf16_f32 v6, v5, v5
    v_and_b32 v6, s7, v6
    v_sub_f32 v5, v5, v6
    v_cvt_pk_bf16_f32 v6, v6, v5
    ds_write_b32 v4, v6 offset:6656
    v_mul_f32 v5, s6, v91
    v_cvt_pk_bf16_f32 v6, v5, v5
    v_and_b32 v6, s7, v6
    v_sub_f32 v5, v5, v6
    v_cvt_pk_bf16_f32 v6, v6, v5
    ds_write_b32 v4, v6 offset:6912
    s_branch L_p3done
L_p3b:
    v_and_b32 v4, 255, v0
    v_lshrrev_b32 v5, 1, v4
    v_mul_u32_u24 v6, 171, v5
    v_lshrrev_b32 v6, 9, v6
    v_add_u32 v6, v6, v5
    v_lshlrev_b32 v6, 2, v6
    v_add_u32 v6, 157648, v6
    v_cmp_gt_u32 vcc, 240, v4
    s_and_saveexec_b64 s[96:97], vcc
    ds_write_b32 v6, v170
    s_mov_b64 exec, s[96:97]
L_p3done:
    v_lshrrev_b32 v4, 3, v1
    s_lshl_b32 s4, s3, 3
    v_add_u32 v4, s4, v4
    s_lshl_b32 s6, s2, 3
    v_lshlrev_b32 v116, 11, v4
    v_add_u32 v116, s6, v116
    v_add_u32 v127, 131072, v116
    v_add_u32 v128, 262144, v116
    v_add_u32 v129, 393216, v116
    v_cmp_gt_u32 vcc, 58, v4
    v_mul_u32_u24 v252, 20480, v4
    v_and_b32 v5, 7, v1
    v_cndmask_b32_e64 v253, 0, -1, vcc
    v_lshlrev_b32 v5, 4, v5
    v_add_u32 v252, v252, v5
    s_add_u32 s4, s28, 5242880
    s_addc_u32 s5, s29, 0
    s_mov_b32 s6, 0x4000
    v_and_b32 v5, 7, v1
    v_lshlrev_b32 v5, 1, v5
    v_add_u32 v108, 0, v5
    v_add_u32 v109, 1, v5
    v_add_u32 v110, 16, v5
    v_add_u32 v111, 17, v5
    v_add_u32 v112, 0, v252
    v_mov_b32 v244, 0
    v_mov_b32 v248, v252
    v_add_u32 v113, 1310720, v252
    v_mov_b32 v245, 0
    v_mov_b32 v249, v252
    v_add_u32 v114, 2621440, v252
    v_mov_b32 v246, 0
    v_mov_b32 v250, v252
    v_add_u32 v115, 3932160, v252
    v_mov_b32 v247, 0
    v_mov_b32 v251, v252
    s_mov_b64 s[64:65], -1
    s_mov_b64 s[66:67], -1
    s_mov_b64 s[68:69], -1
    v_cmp_ne_u32 s[70:71], 0, v253
    s_mov_b64 exec, s[64:65]
    global_load_dwordx2 v[100:101], v116, s[4:5] sc1
    s_mov_b64 exec, s[66:67]
    global_load_dwordx2 v[102:103], v127, s[4:5] sc1
    s_mov_b64 exec, s[68:69]
    global_load_dwordx2 v[104:105], v128, s[4:5] sc1
    s_mov_b64 exec, s[70:71]
    global_load_dwordx2 v[106:107], v129, s[4:5] sc1
    s_mov_b64 exec, -1
    s_waitcnt vmcnt(0)
L_poll:
    v_xor_b32 v136, s31, v100
    v_lshrrev_b32 v136, 24, v136
    v_xor_b32 v4, s30, v101
    v_or_b32 v136, v136, v4
    v_xor_b32 v137, s31, v102
    v_lshrrev_b32 v137, 24, v137
    v_xor_b32 v4, s30, v103
    v_or_b32 v137, v137, v4
    v_xor_b32 v138, s31, v104
    v_lshrrev_b32 v138, 24, v138
    v_xor_b32 v4, s30, v105
    v_or_b32 v138, v138, v4
    v_xor_b32 v139, s31, v106
    v_lshrrev_b32 v139, 24, v139
    v_xor_b32 v4, s30, v107
    v_or_b32 v139, v139, v4
    v_cmp_eq_u32 s[72:73], 0, v136
    v_cmp_eq_u32 s[74:75], 0, v137
    v_cmp_eq_u32 s[76:77], 0, v138
    v_cmp_eq_u32 s[78:79], 0, v139
    s_and_b64 s[80:81], s[64:65], s[72:73]
    s_andn2_b64 s[64:65], s[64:65], s[72:73]
    s_mov_b64 exec, s[80:81]
    v_and_b32 v4, 0xfff, v100
    v_bfe_u32 v244, v100, 12, 12
    v_lshl_add_u32 v248, v4, 3, v112
    s_and_b64 s[82:83], s[66:67], s[74:75]
    s_andn2_b64 s[66:67], s[66:67], s[74:75]
    s_mov_b64 exec, s[82:83]
    v_and_b32 v4, 0xfff, v102
    v_bfe_u32 v245, v102, 12, 12
    v_lshl_add_u32 v249, v4, 3, v113
    s_and_b64 s[84:85], s[68:69], s[76:77]
    s_andn2_b64 s[68:69], s[68:69], s[76:77]
    s_mov_b64 exec, s[84:85]
    v_and_b32 v4, 0xfff, v104
    v_bfe_u32 v246, v104, 12, 12
    v_lshl_add_u32 v250, v4, 3, v114
    s_and_b64 s[86:87], s[70:71], s[78:79]
    s_andn2_b64 s[70:71], s[70:71], s[78:79]
    s_mov_b64 exec, s[86:87]
    v_and_b32 v4, 0xfff, v106
    v_bfe_u32 v247, v106, 12, 12
    v_lshl_add_u32 v251, v4, 3, v115
    s_mov_b64 exec, s[64:65]
    global_load_dwordx2 v[100:101], v116, s[4:5] sc1
    s_mov_b64 exec, s[66:67]
    global_load_dwordx2 v[102:103], v127, s[4:5] sc1
    s_mov_b64 exec, s[68:69]
    global_load_dwordx2 v[104:105], v128, s[4:5] sc1
    s_mov_b64 exec, s[70:71]
    global_load_dwordx2 v[106:107], v129, s[4:5] sc1
    s_mov_b64 exec, -1
    s_mov_b64 exec, s[80:81]
    v_cmp_lt_u32 vcc, v108, v244
    v_cmp_lt_u32 s[96:97], v110, v244
    s_mov_b64 exec, vcc
    global_load_dwordx4 v[28:31], v248, s[28:29] sc1
    s_mov_b64 exec, s[96:97]
    global_load_dwordx4 v[44:47], v248, s[28:29] offset:128 sc1
    s_mov_b64 exec, s[82:83]
    v_cmp_lt_u32 vcc, v108, v245
    v_cmp_lt_u32 s[96:97], v110, v245
    s_mov_b64 exec, vcc
    global_load_dwordx4 v[32:35], v249, s[28:29] sc1
    s_mov_b64 exec, s[96:97]
    global_load_dwordx4 v[48:51], v249, s[28:29] offset:128 sc1
    s_mov_b64 exec, s[84:85]
    v_cmp_lt_u32 vcc, v108, v246
    v_cmp_lt_u32 s[96:97], v110, v246
    s_mov_b64 exec, vcc
    global_load_dwordx4 v[36:39], v250, s[28:29] sc1
    s_mov_b64 exec, s[96:97]
    global_load_dwordx4 v[52:55], v250, s[28:29] offset:128 sc1
    s_mov_b64 exec, s[86:87]
    v_cmp_lt_u32 vcc, v108, v247
    v_cmp_lt_u32 s[96:97], v110, v247
    s_mov_b64 exec, vcc
    global_load_dwordx4 v[40:43], v251, s[28:29] sc1
    s_mov_b64 exec, s[96:97]
    global_load_dwordx4 v[56:59], v251, s[28:29] offset:128 sc1
    s_mov_b64 exec, -1
    s_or_b64 s[96:97], s[64:65], s[66:67]
    s_or_b64 s[98:99], s[68:69], s[70:71]
    s_or_b64 s[96:97], s[96:97], s[98:99]
    s_cbranch_scc0 L_polldone
    s_sub_u32 s6, s6, 1
    s_cmp_eq_u32 s6, 0
    s_cbranch_scc1 L_giveup
    s_waitcnt vmcnt(8)
    s_branch L_poll
L_giveup:
    s_endpgm
L_polldone:
    s_mov_b32 s58, 0
    s_mov_b32 s59, 0
    s_mov_b32 s60, 0
    s_mov_b32 s63, 1
    v_cmp_lt_u32 s[64:65], v108, v244
    v_cmp_lt_u32 s[66:67], v109, v244
    v_cmp_lt_u32 s[68:69], v108, v245
    v_cmp_lt_u32 s[70:71], v109, v245
    v_cmp_lt_u32 s[72:73], v108, v246
    v_cmp_lt_u32 s[74:75], v109, v246
    v_cmp_lt_u32 s[76:77], v108, v247
    v_cmp_lt_u32 s[78:79], v109, v247
    v_cmp_lt_u32 s[80:81], v110, v244
    v_cmp_lt_u32 s[82:83], v111, v244
    v_cmp_lt_u32 s[84:85], v110, v245
    v_cmp_lt_u32 s[86:87], v111, v245
    v_cmp_lt_u32 s[88:89], v110, v246
    v_cmp_lt_u32 s[90:91], v111, v246
    v_cmp_lt_u32 s[92:93], v110, v247
    v_cmp_lt_u32 s[94:95], v111, v247
    s_branch L_loadsdone
L_batch:
    v_and_b32 v5, 7, v1
    v_lshlrev_b32 v5, 1, v5
    v_add_u32 v108, 0, v5
    v_add_u32 v109, 1, v5
    v_add_u32 v110, 16, v5
    v_add_u32 v111, 17, v5
    s_lshl_b32 s4, s59, 5
    s_lshl_b32 s6, s59, 8
    v_subrev_u32 v4, s4, v244
    v_max_i32 v4, 0, v4
    s_cmp_eq_u32 s60, 0
    s_cselect_b32 s5, -1, 0
    v_and_b32 v112, s5, v4
    v_add_u32 v136, s6, v248
    v_subrev_u32 v4, s4, v245
    v_max_i32 v4, 0, v4
    s_cmp_eq_u32 s60, 1
    s_cselect_b32 s5, -1, 0
    v_and_b32 v113, s5, v4
    v_add_u32 v137, s6, v249
    v_subrev_u32 v4, s4, v246
    v_max_i32 v4, 0, v4
    s_cmp_eq_u32 s60, 2
    s_cselect_b32 s5, -1, 0
    v_and_b32 v114, s5, v4
    v_add_u32 v138, s6, v250
    v_subrev_u32 v4, s4, v247
    v_max_i32 v4, 0, v4
    s_cmp_eq_u32 s60, 3
    s_cselect_b32 s5, -1, 0
    v_and_b32 v115, s5, v4
    v_add_u32 v139, s6, v251
    v_cmp_lt_u32 s[64:65], v108, v112
    v_cmp_lt_u32 s[66:67], v109, v112
    v_cmp_lt_u32 s[68:69], v108, v113
    v_cmp_lt_u32 s[70:71], v109, v113
    v_cmp_lt_u32 s[72:73], v108, v114
    v_cmp_lt_u32 s[74:75], v109, v114
    v_cmp_lt_u32 s[76:77], v108, v115
    v_cmp_lt_u32 s[78:79], v109, v115
    v_cmp_lt_u32 s[80:81], v110, v112
    v_cmp_lt_u32 s[82:83], v111, v112
    v_cmp_lt_u32 s[84:85], v110, v113
    v_cmp_lt_u32 s[86:87], v111, v113
    v_cmp_lt_u32 s[88:89], v110, v114
    v_cmp_lt_u32 s[90:91], v111, v114
    v_cmp_lt_u32 s[92:93], v110, v115
    v_cmp_lt_u32 s[94:95], v111, v115
    s_mov_b64 exec, s[64:65]
    global_load_dwordx4 v[28:31], v136, s[28:29] offset:0 sc1
    s_mov_b64 exec, s[68:69]
    global_load_dwordx4 v[32:35], v137, s[28:29] offset:0 sc1
    s_mov_b64 exec, s[72:73]
    global_load_dwordx4 v[36:39], v138, s[28:29] offset:0 sc1
    s_mov_b64 exec, s[76:77]
    global_load_dwordx4 v[40:43], v139, s[28:29] offset:0 sc1
    s_mov_b64 exec, s[80:81]
    global_load_dwordx4 v[44:47], v136, s[28:29] offset:128 sc1
    s_mov_b64 exec, s[84:85]
    global_load_dwordx4 v[48:51], v137, s[28:29] offset:128 sc1
    s_mov_b64 exec, s[88:89]
    global_load_dwordx4 v[52:55], v138, s[28:29] offset:128 sc1
    s_mov_b64 exec, s[92:93]
    global_load_dwordx4 v[56:59], v139, s[28:29] offset:128 sc1
    s_mov_b64 exec, -1
L_loadsdone:
    s_cmp_eq_u32 s63, 0
    s_cbranch_scc1 L_nomax
    v_max_u32 v4, v244, v245
    v_max3_u32 v4, v4, v246, v247
    v_mov_b32 v5, 60928
    s_mov_b32 s4, 0x01010101
    s_mov_b32 s5, 0x01010101
    s_mov_b64 exec, s[4:5]
    ds_max_u32 v5, v4
    s_mov_b64 exec, -1
L_nomax:
    s_waitcnt vmcnt(0)
    s_mov_b64 exec, s[64:65]
    ds_add_rtn_u32 v60, v29, v171 offset:60416
    s_mov_b64 exec, s[66:67]
    ds_add_rtn_u32 v61, v31, v171 offset:60416
    s_mov_b64 exec, s[68:69]
    ds_add_rtn_u32 v62, v33, v171 offset:60416
    s_mov_b64 exec, s[70:71]
    ds_add_rtn_u32 v63, v35, v171 offset:60416
    s_mov_b64 exec, s[72:73]
    ds_add_rtn_u32 v64, v37, v171 offset:60416
    s_mov_b64 exec, s[74:75]
    ds_add_rtn_u32 v65, v39, v171 offset:60416
    s_mov_b64 exec, s[76:77]
    ds_add_rtn_u32 v66, v41, v171 offset:60416
    s_mov_b64 exec, s[78:79]
    ds_add_rtn_u32 v67, v43, v171 offset:60416
    s_cmp_eq_u64 s[80:81], 0
    s_cbranch_scc1 L_ska0
    s_mov_b64 exec, s[80:81]
    ds_add_rtn_u32 v68, v45, v171 offset:60416
    s_mov_b64 exec, s[82:83]
    ds_add_rtn_u32 v69, v47, v171 offset:60416
L_ska0:
    s_cmp_eq_u64 s[84:85], 0
    s_cbranch_scc1 L_ska1
    s_mov_b64 exec, s[84:85]
    ds_add_rtn_u32 v70, v49, v171 offset:60416
    s_mov_b64 exec, s[86:87]
    ds_add_rtn_u32 v71, v51, v171 offset:60416
L_ska1:
    s_cmp_eq_u64 s[88:89], 0
    s_cbranch_scc1 L_ska2
    s_mov_b64 exec, s[88:89]
    ds_add_rtn_u32 v72, v53, v171 offset:60416
    s_mov_b64 exec, s[90:91]
    ds_add_rtn_u32 v73, v55, v171 offset:60416
L_ska2:
    s_cmp_eq_u64 s[92:93], 0
    s_cbranch_scc1 L_ska3
    s_mov_b64 exec, s[92:93]
    ds_add_rtn_u32 v74, v57, v171 offset:60416
    s_mov_b64 exec, s[94:95]
    ds_add_rtn_u32 v75, v59, v171 offset:60416
L_ska3:
    s_mov_b64 exec, -1
    s_waitcnt lgkmcnt(0)
    s_barrier
    s_cmp_eq_u32 s63, 0
    s_cbranch_scc1 L_noep
    s_or_b32 s4, s2, s3
    s_cmp_lg_u32 s4, 0
    s_cbranch_scc1 L_noep
    s_add_u32 s4, s28, 6029312
    s_addc_u32 s5, s29, 0
    v_mov_b32 v4, s100
    v_mov_b32 v5, s101
    v_mov_b32 v6, 0
    s_mov_b64 exec, 1
    global_store_dwordx2 v6, v[4:5], s[4:5] sc1
    s_mov_b64 exec, -1
L_noep:
    s_mov_b32 s63, 0
    v_lshlrev_b32 v4, 2, v1
    ds_read_b32 v5, v4 offset:60416
    ds_read_b32 v7, v171 offset:60927
    v_cmp_gt_u32 s[98:99], 40, v1
    v_mul_u32_u24 v94, 43, v1
    v_lshrrev_b32 v94, 9, v94
    v_mul_u32_u24 v95, 12, v94
    v_sub_u32 v95, v1, v95
    s_mul_i32 s5, s3, 5
    v_add_u32 v94, s5, v94
    v_min_u32 v94, 39, v94
    v_lshlrev_b32 v138, 18, v94
    v_lshlrev_b32 v139, 8, v94
    v_lshlrev_b32 v96, 2, v94
    v_add_u32 v97, 4, v96
    s_waitcnt lgkmcnt(0)
    v_add_u32 v5, 7, v5
    v_and_b32 v5, -8, v5
    v_max_u32 v5, 8, v5
    v_cndmask_b32_e64 v5, 0, v5, s[98:99]
    v_mov_b32 v136, v5
    s_nop 1
    v_add_u32_dpp v136, v136, v136 row_shr:1 row_mask:0xf bank_mask:0xf bound_ctrl:0
    s_nop 1
    v_add_u32_dpp v136, v136, v136 row_shr:2 row_mask:0xf bank_mask:0xf bound_ctrl:0
    s_nop 1
    v_add_u32_dpp v136, v136, v136 row_shr:4 row_mask:0xf bank_mask:0xf bound_ctrl:0
    s_nop 1
    v_add_u32_dpp v136, v136, v136 row_shr:8 row_mask:0xf bank_mask:0xf bound_ctrl:0
    s_nop 1
    v_add_u32_dpp v136, v136, v136 row_bcast:15 row_mask:0xa bank_mask:0xf
    s_nop 1
    v_add_u32_dpp v136, v136, v136 row_bcast:31 row_mask:0xc bank_mask:0xf
    v_sub_u32 v92, v136, v5
    v_readfirstlane_b32 s61, v7
    v_readlane_b32 s62, v136, 63
    v_lshlrev_b32 v93, 2, v92
    v_add_u32 v93, 145104, v93
    s_cmp_lg_u32 s58, 0
    s_cbranch_scc1 L_noovf
    s_cmp_gt_u32 s62, 3040
    s_cbranch_scc1 L_ovf
    s_cmp_gt_u32 s61, 32
    s_cbranch_scc0 L_noovf
L_ovf:
    s_mov_b32 s58, 1
    s_waitcnt lgkmcnt(0)
    s_barrier
    v_lshlrev_b32 v4, 2, v1
    v_mov_b32 v5, 0
    ds_write_b32 v4, v5 offset:60416
    s_waitcnt lgkmcnt(0)
    s_barrier
    s_branch L_batch
L_noovf:
    ds_bpermute_b32 v136, v96, v92
    ds_bpermute_b32 v137, v97, v92
    ds_bpermute_b32 v76, v29, v93
    ds_bpermute_b32 v77, v31, v93
    ds_bpermute_b32 v78, v33, v93
    ds_bpermute_b32 v79, v35, v93
    ds_bpermute_b32 v80, v37, v93
    ds_bpermute_b32 v81, v39, v93
    ds_bpermute_b32 v82, v41, v93
    ds_bpermute_b32 v83, v43, v93
    s_cmp_eq_u64 s[80:81], 0
    s_cbranch_scc1 L_skr0
    ds_bpermute_b32 v84, v45, v93
    ds_bpermute_b32 v85, v47, v93
L_skr0:
    s_cmp_eq_u64 s[84:85], 0
    s_cbranch_scc1 L_skr1
    ds_bpermute_b32 v86, v49, v93
    ds_bpermute_b32 v87, v51, v93
L_skr1:
    s_cmp_eq_u64 s[88:89], 0
    s_cbranch_scc1 L_skr2
    ds_bpermute_b32 v88, v53, v93
    ds_bpermute_b32 v89, v55, v93
L_skr2:
    s_cmp_eq_u64 s[92:93], 0
    s_cbranch_scc1 L_skr3
    ds_bpermute_b32 v90, v57, v93
    ds_bpermute_b32 v91, v59, v93
L_skr3:
    s_add_u32 s41, s62, 31
    s_lshr_b32 s41, s41, 5
    v_cndmask_b32_e64 v98, -1, v92, s[98:99]
    s_mul_i32 s4, s3, s41
    s_lshr_b32 s5, s4, 3
    s_add_u32 s4, s4, s41
    s_lshr_b32 s4, s4, 3
    s_sub_u32 s55, s4, s5
    s_lshl_b32 s56, s5, 5
    s_lshl_b32 s4, s4, 5
    v_cmp_ge_u32 vcc, s56, v98
    s_bcnt1_i32_b64 s42, vcc
    v_cmp_ge_u32 vcc, s4, v98
    s_bcnt1_i32_b64 s5, vcc
    s_sub_u32 s5, s5, s42
    s_sub_u32 s42, s42, 1
    s_cmp_eq_u32 s3, 7
    s_cselect_b32 s4, 1, 0
    s_add_u32 s5, s5, s4
    s_add_u32 s4, s4, 6
    s_sub_u32 s5, s5, 1
    s_cmp_gt_u32 s5, s4
    s_cselect_b32 s4, 1, 0
    s_lshl_b32 s5, s3, 2
    s_add_u32 s5, s5, 60944
    v_mov_b32 v99, s5
    v_mov_b32 v100, s42
    v_mov_b32 v101, 60932
    v_mov_b32 v102, s4
    s_mov_b64 exec, 1
    ds_write_b32 v99, v100
    ds_or_b32 v101, v102
    s_mov_b64 exec, -1
    s_mul_i32 s4, s3, 5
    s_add_u32 s5, s4, 5
    v_readlane_b32 s96, v92, s4
    v_readlane_b32 s97, v92, s5
    v_cmp_eq_u32 vcc, 39, v94
    s_waitcnt lgkmcnt(0)
    s_nop 0
    v_cndmask_b32_e64 v7, 0, 4, vcc
    v_lshrrev_b32 v136, 3, v136
    v_lshrrev_b32 v137, 3, v137
    v_add_u32 v136, v136, v95
    v_add_u32 v137, v137, v7
    v_cmp_gt_u32 vcc, 60, v1
    s_mov_b64 s[98:99], vcc
L_gmfill:
    v_cmp_lt_u32 vcc, v136, v137
    s_and_b64 vcc, vcc, s[98:99]
    s_cbranch_vccz L_gmdone
    s_mov_b64 exec, vcc
    v_lshlrev_b32 v6, 3, v136
    ds_write_b64 v6, v[138:139] offset:63040
    s_mov_b64 exec, -1
    v_add_u32 v136, 12, v136
    s_branch L_gmfill
L_gmdone:
    s_mov_b64 exec, s[64:65]
    v_lshl_add_u32 v76, v60, 2, v76
    ds_write_b32 v76, v28
    s_mov_b64 exec, s[66:67]
    v_lshl_add_u32 v77, v61, 2, v77
    ds_write_b32 v77, v30
    s_mov_b64 exec, s[68:69]
    v_lshl_add_u32 v78, v62, 2, v78
    ds_write_b32 v78, v32
    s_mov_b64 exec, s[70:71]
    v_lshl_add_u32 v79, v63, 2, v79
    ds_write_b32 v79, v34
    s_mov_b64 exec, s[72:73]
    v_lshl_add_u32 v80, v64, 2, v80
    ds_write_b32 v80, v36
    s_mov_b64 exec, s[74:75]
    v_lshl_add_u32 v81, v65, 2, v81
    ds_write_b32 v81, v38
    s_mov_b64 exec, s[76:77]
    v_lshl_add_u32 v82, v66, 2, v82
    ds_write_b32 v82, v40
    s_mov_b64 exec, s[78:79]
    v_lshl_add_u32 v83, v67, 2, v83
    ds_write_b32 v83, v42
    s_cmp_eq_u64 s[80:81], 0
    s_cbranch_scc1 L_skw0
    s_mov_b64 exec, s[80:81]
    v_lshl_add_u32 v84, v68, 2, v84
    ds_write_b32 v84, v44
    s_mov_b64 exec, s[82:83]
    v_lshl_add_u32 v85, v69, 2, v85
    ds_write_b32 v85, v46
L_skw0:
    s_cmp_eq_u64 s[84:85], 0
    s_cbranch_scc1 L_skw1
    s_mov_b64 exec, s[84:85]
    v_lshl_add_u32 v86, v70, 2, v86
    ds_write_b32 v86, v48
    s_mov_b64 exec, s[86:87]
    v_lshl_add_u32 v87, v71, 2, v87
    ds_write_b32 v87, v50
L_skw1:
    s_cmp_eq_u64 s[88:89], 0
    s_cbranch_scc1 L_skw2
    s_mov_b64 exec, s[88:89]
    v_lshl_add_u32 v88, v72, 2, v88
    ds_write_b32 v88, v52
    s_mov_b64 exec, s[90:91]
    v_lshl_add_u32 v89, v73, 2, v89
    ds_write_b32 v89, v54
L_skw2:
    s_cmp_eq_u64 s[92:93], 0
    s_cbranch_scc1 L_skw3
    s_mov_b64 exec, s[92:93]
    v_lshl_add_u32 v90, v74, 2, v90
    ds_write_b32 v90, v56
    s_mov_b64 exec, s[94:95]
    v_lshl_add_u32 v91, v75, 2, v91
    ds_write_b32 v91, v58
L_skw3:
    s_mov_b64 exec, -1
    s_waitcnt vmcnt(0) lgkmcnt(0)
    s_barrier
    v_mov_b32 v4, 60932
    ds_read_b32 v5, v4
    s_sub_u32 s97, s97, s96
    s_add_u32 s97, s97, 31
    s_lshr_b32 s97, s97, 5
    s_mul_i32 s6, s3, 5
    s_waitcnt lgkmcnt(0)
    v_readfirstlane_b32 s40, v5
    s_nop 0
    s_or_b32 s40, s40, s58
    s_cmp_eq_u32 s40, 0
    s_cselect_b32 s56, s56, s96
    s_cselect_b32 s55, s55, s97
    s_cselect_b32 s42, s42, s6
    s_lshl_b32 s4, s56, 2
    s_add_u32 s4, s4, 145104
    v_add_u32 v156, s4, v168
    v_lshlrev_b32 v4, 2, v169
    v_add_u32 v157, s4, v4
    s_lshl_b32 s6, s56, 1
    s_add_u32 s7, s6, 90816
    v_lshlrev_b32 v4, 1, v169
    v_add_u32 v158, s7, v4
    s_lshl_b32 s7, s42, 18
    s_sub_u32 s6, s6, s7
    v_add_u32 v160, s6, v210
    s_add_u32 s7, s56, 63040
    v_lshlrev_b32 v4, 3, v3
    v_add_u32 v159, s7, v4
    ds_read_u16 v140, v156 offset:0
    ds_read_u16 v142, v156 offset:16
    ds_read_u16 v144, v156 offset:64
    ds_read_u16 v146, v156 offset:80
    ds_read_b64 v[152:153], v159
    ds_read_b64 v[154:155], v159 offset:16
    s_lshl_b32 s54, s55, 4
    v_mov_b32 v136, v1
    s_waitcnt lgkmcnt(0)
    s_add_u32 m0, s57, 0
    s_nop 0
    buffer_load_dwordx4 v[140:141], s[48:51], 0 idxen offen sc1 lds
    s_add_u32 m0, s57, 1024
    s_nop 0
    buffer_load_dwordx4 v[142:143], s[48:51], 0 idxen offen sc1 lds
    s_add_u32 m0, s57, 2048
    s_nop 0
    buffer_load_dwordx4 v[144:145], s[48:51], 0 idxen offen sc1 lds
    s_add_u32 m0, s57, 3072
    s_nop 0
    buffer_load_dwordx4 v[146:147], s[48:51], 0 idxen offen sc1 lds
    v_add_u32 v156, 128, v156
L_pb:
    s_lshl_b32 s4, s56, 2
    s_add_u32 s4, s4, 145104
    s_add_u32 s5, s56, 63044
    s_lshl_b32 s6, s56, 1
    s_add_u32 s6, s6, 66176
    s_mov_b32 s7, 0xffff0000
    s_mov_b32 s96, 60000
    s_mov_b32 s97, 0xffff
    v_add_u32 v4, 0, v136
    v_cmp_gt_u32 vcc, s54, v4
    s_mov_b64 s[64:65], vcc
    v_lshl_add_u32 v5, v4, 3, s4
    v_lshrrev_b32 v6, 2, v4
    v_lshl_add_u32 v6, v6, 3, s5
    v_lshl_add_u32 v31, v4, 2, s6
    s_mov_b64 exec, s[64:65]
    ds_read_b64 v[28:29], v5
    ds_read_b32 v30, v6
    s_mov_b64 exec, -1
    v_add_u32 v4, 64, v136
    v_cmp_gt_u32 vcc, s54, v4
    s_mov_b64 s[66:67], vcc
    v_lshl_add_u32 v5, v4, 3, s4
    v_lshrrev_b32 v6, 2, v4
    v_lshl_add_u32 v6, v6, 3, s5
    v_lshl_add_u32 v67, v4, 2, s6
    s_mov_b64 exec, s[66:67]
    ds_read_b64 v[64:65], v5
    ds_read_b32 v66, v6
    s_mov_b64 exec, -1
    v_add_u32 v4, 128, v136
    v_cmp_gt_u32 vcc, s54, v4
    s_mov_b64 s[68:69], vcc
    v_lshl_add_u32 v5, v4, 3, s4
    v_lshrrev_b32 v6, 2, v4
    v_lshl_add_u32 v6, v6, 3, s5
    v_lshl_add_u32 v103, v4, 2, s6
    s_mov_b64 exec, s[68:69]
    ds_read_b64 v[100:101], v5
    ds_read_b32 v102, v6
    s_mov_b64 exec, -1
    s_waitcnt lgkmcnt(4)
    s_mov_b64 exec, s[64:65]
    v_lshrrev_b32 v4, 4, v30
    v_add_u32 v4, 157648, v4
    ds_read_b128 v[32:35], v4
    v_mov_b32 v5, 6
    v_mul_u32_u24_sdwa v36, v28, v5 dst_sel:DWORD dst_unused:UNUSED_PAD src0_sel:WORD_0 src1_sel:DWORD
    v_mul_u32_u24_sdwa v37, v29, v5 dst_sel:DWORD dst_unused:UNUSED_PAD src0_sel:WORD_0 src1_sel:DWORD
    v_cmp_ne_u32 vcc, s96, v36
    s_mov_b64 s[72:73], vcc
    v_lshlrev_b32 v38, 3, v36
    v_and_b32 v36, -4, v36
    ds_read2_b32 v[40:41], v36 offset0:0 offset1:1
    v_cmp_ne_u32 vcc, s96, v37
    s_mov_b64 s[74:75], vcc
    v_lshlrev_b32 v39, 3, v37
    v_and_b32 v37, -4, v37
    ds_read2_b32 v[42:43], v37 offset0:0 offset1:1
    s_mov_b64 exec, -1
    s_waitcnt lgkmcnt(5)
    s_mov_b64 exec, s[66:67]
    v_lshrrev_b32 v4, 4, v66
    v_add_u32 v4, 157648, v4
    ds_read_b128 v[68:71], v4
    v_mov_b32 v5, 6
    v_mul_u32_u24_sdwa v72, v64, v5 dst_sel:DWORD dst_unused:UNUSED_PAD src0_sel:WORD_0 src1_sel:DWORD
    v_mul_u32_u24_sdwa v73, v65, v5 dst_sel:DWORD dst_unused:UNUSED_PAD src0_sel:WORD_0 src1_sel:DWORD
    v_cmp_ne_u32 vcc, s96, v72
    s_mov_b64 s[76:77], vcc
    v_lshlrev_b32 v74, 3, v72
    v_and_b32 v72, -4, v72
    ds_read2_b32 v[76:77], v72 offset0:0 offset1:1
    v_cmp_ne_u32 vcc, s96, v73
    s_mov_b64 s[78:79], vcc
    v_lshlrev_b32 v75, 3, v73
    v_and_b32 v73, -4, v73
    ds_read2_b32 v[78:79], v73 offset0:0 offset1:1
    s_mov_b64 exec, -1
    s_waitcnt lgkmcnt(6)
    s_mov_b64 exec, s[68:69]
    v_lshrrev_b32 v4, 4, v102
    v_add_u32 v4, 157648, v4
    ds_read_b128 v[104:107], v4
    v_mov_b32 v5, 6
    v_mul_u32_u24_sdwa v108, v100, v5 dst_sel:DWORD dst_unused:UNUSED_PAD src0_sel:WORD_0 src1_sel:DWORD
    v_mul_u32_u24_sdwa v109, v101, v5 dst_sel:DWORD dst_unused:UNUSED_PAD src0_sel:WORD_0 src1_sel:DWORD
    v_cmp_ne_u32 vcc, s96, v108
    s_mov_b64 s[80:81], vcc
    v_lshlrev_b32 v110, 3, v108
    v_and_b32 v108, -4, v108
    ds_read2_b32 v[112:113], v108 offset0:0 offset1:1
    v_cmp_ne_u32 vcc, s96, v109
    s_mov_b64 s[82:83], vcc
    v_lshlrev_b32 v111, 3, v109
    v_and_b32 v109, -4, v109
    ds_read2_b32 v[114:115], v109 offset0:0 offset1:1
    s_mov_b64 exec, -1
    s_waitcnt lgkmcnt(6)
    s_mov_b64 exec, s[64:65]
    v_alignbit_b32 v4, v41, v40, v38
    v_lshrrev_b32 v5, v38, v41
    v_lshlrev_b32 v44, 16, v4
    v_and_b32 v46, s7, v4
    v_lshlrev_b32 v48, 16, v5
    v_alignbit_b32 v4, v43, v42, v39
    v_lshrrev_b32 v5, v39, v43
    v_lshlrev_b32 v45, 16, v4
    v_and_b32 v47, s7, v4
    v_lshlrev_b32 v49, 16, v5
    v_pk_add_f32 v[44:45], v[32:33], v[44:45] op_sel:[0,0] op_sel_hi:[0,1] neg_lo:[0,1] neg_hi:[0,1]
    v_pk_add_f32 v[46:47], v[32:33], v[46:47] op_sel:[1,0] op_sel_hi:[1,1] neg_lo:[0,1] neg_hi:[0,1]
    v_pk_add_f32 v[48:49], v[34:35], v[48:49] op_sel:[0,0] op_sel_hi:[0,1] neg_lo:[0,1] neg_hi:[0,1]
    v_mov_b32 v4, s97
    v_cndmask_b32_e64 v53, 0, v4, s[72:73]
    v_mov_b32 v5, s7
    v_cndmask_b32_e64 v4, 0, v5, s[74:75]
    v_or_b32 v53, v53, v4
    v_cvt_pk_bf16_f32 v50, v44, v45
    v_and_b32 v50, v50, v53
    v_cvt_pk_bf16_f32 v51, v46, v47
    v_and_b32 v51, v51, v53
    v_cvt_pk_bf16_f32 v52, v48, v49
    v_and_b32 v52, v52, v53
    v_lshlrev_b32 v44, 16, v50
    v_and_b32 v45, s7, v50
    v_lshlrev_b32 v46, 16, v51
    v_and_b32 v47, s7, v51
    v_lshlrev_b32 v48, 16, v52
    v_and_b32 v49, s7, v52
    v_pk_mul_f32 v[54:55], v[44:45], v[44:45]
    v_pk_fma_f32 v[54:55], v[46:47], v[46:47], v[54:55]
    v_pk_fma_f32 v[54:55], v[48:49], v[48:49], v[54:55]
    v_and_b32 v57, 0x3f803f80, v53
    v_cvt_pk_bf16_f32 v56, v54, v55
    ds_write_b32 v31, v57
    ds_write_b32 v31, v50 offset:6160
    ds_write_b32 v31, v51 offset:12320
    ds_write_b32 v31, v52 offset:18480
    ds_write_b32 v31, v56 offset:24640
    s_mov_b64 exec, -1
    s_waitcnt lgkmcnt(8)
    s_mov_b64 exec, s[66:67]
    v_alignbit_b32 v4, v77, v76, v74
    v_lshrrev_b32 v5, v74, v77
    v_lshlrev_b32 v80, 16, v4
    v_and_b32 v82, s7, v4
    v_lshlrev_b32 v84, 16, v5
    v_alignbit_b32 v4, v79, v78, v75
    v_lshrrev_b32 v5, v75, v79
    v_lshlrev_b32 v81, 16, v4
    v_and_b32 v83, s7, v4
    v_lshlrev_b32 v85, 16, v5
    v_pk_add_f32 v[80:81], v[68:69], v[80:81] op_sel:[0,0] op_sel_hi:[0,1] neg_lo:[0,1] neg_hi:[0,1]
    v_pk_add_f32 v[82:83], v[68:69], v[82:83] op_sel:[1,0] op_sel_hi:[1,1] neg_lo:[0,1] neg_hi:[0,1]
    v_pk_add_f32 v[84:85], v[70:71], v[84:85] op_sel:[0,0] op_sel_hi:[0,1] neg_lo:[0,1] neg_hi:[0,1]
    v_mov_b32 v4, s97
    v_cndmask_b32_e64 v89, 0, v4, s[76:77]
    v_mov_b32 v5, s7
    v_cndmask_b32_e64 v4, 0, v5, s[78:79]
    v_or_b32 v89, v89, v4
    v_cvt_pk_bf16_f32 v86, v80, v81
    v_and_b32 v86, v86, v89
    v_cvt_pk_bf16_f32 v87, v82, v83
    v_and_b32 v87, v87, v89
    v_cvt_pk_bf16_f32 v88, v84, v85
    v_and_b32 v88, v88, v89
    v_lshlrev_b32 v80, 16, v86
    v_and_b32 v81, s7, v86
    v_lshlrev_b32 v82, 16, v87
    v_and_b32 v83, s7, v87
    v_lshlrev_b32 v84, 16, v88
    v_and_b32 v85, s7, v88
    v_pk_mul_f32 v[90:91], v[80:81], v[80:81]
    v_pk_fma_f32 v[90:91], v[82:83], v[82:83], v[90:91]
    v_pk_fma_f32 v[90:91], v[84:85], v[84:85], v[90:91]
    v_and_b32 v93, 0x3f803f80, v89
    v_cvt_pk_bf16_f32 v92, v90, v91
    ds_write_b32 v67, v93
    ds_write_b32 v67, v86 offset:6160
    ds_write_b32 v67, v87 offset:12320
    ds_write_b32 v67, v88 offset:18480
    ds_write_b32 v67, v92 offset:24640
    s_mov_b64 exec, -1
    s_waitcnt lgkmcnt(10)
    s_mov_b64 exec, s[68:69]
    v_alignbit_b32 v4, v113, v112, v110
    v_lshrrev_b32 v5, v110, v113
    v_lshlrev_b32 v116, 16, v4
    v_and_b32 v118, s7, v4
    v_lshlrev_b32 v120, 16, v5
    v_alignbit_b32 v4, v115, v114, v111
    v_lshrrev_b32 v5, v111, v115
    v_lshlrev_b32 v117, 16, v4
    v_and_b32 v119, s7, v4
    v_lshlrev_b32 v121, 16, v5
    v_pk_add_f32 v[116:117], v[104:105], v[116:117] op_sel:[0,0] op_sel_hi:[0,1] neg_lo:[0,1] neg_hi:[0,1]
    v_pk_add_f32 v[118:119], v[104:105], v[118:119] op_sel:[1,0] op_sel_hi:[1,1] neg_lo:[0,1] neg_hi:[0,1]
    v_pk_add_f32 v[120:121], v[106:107], v[120:121] op_sel:[0,0] op_sel_hi:[0,1] neg_lo:[0,1] neg_hi:[0,1]
    v_mov_b32 v4, s97
    v_cndmask_b32_e64 v125, 0, v4, s[80:81]
    v_mov_b32 v5, s7
    v_cndmask_b32_e64 v4, 0, v5, s[82:83]
    v_or_b32 v125, v125, v4
    v_cvt_pk_bf16_f32 v122, v116, v117
    v_and_b32 v122, v122, v125
    v_cvt_pk_bf16_f32 v123, v118, v119
    v_and_b32 v123, v123, v125
    v_cvt_pk_bf16_f32 v124, v120, v121
    v_and_b32 v124, v124, v125
    v_lshlrev_b32 v116, 16, v122
    v_and_b32 v117, s7, v122
    v_lshlrev_b32 v118, 16, v123
    v_and_b32 v119, s7, v123
    v_lshlrev_b32 v120, 16, v124
    v_and_b32 v121, s7, v124
    v_pk_mul_f32 v[126:127], v[116:117], v[116:117]
    v_pk_fma_f32 v[126:127], v[118:119], v[118:119], v[126:127]
    v_pk_fma_f32 v[126:127], v[120:121], v[120:121], v[126:127]
    v_and_b32 v129, 0x3f803f80, v125
    v_cvt_pk_bf16_f32 v128, v126, v127
    ds_write_b32 v103, v129
    ds_write_b32 v103, v122 offset:6160
    ds_write_b32 v103, v123 offset:12320
    ds_write_b32 v103, v124 offset:18480
    ds_write_b32 v103, v128 offset:24640
    s_mov_b64 exec, -1
    v_add_u32 v136, 192, v136
    s_nop 0
    v_readfirstlane_b32 s4, v136
    s_nop 0
    s_cmp_lt_u32 s4, s54
    s_cbranch_scc1 L_pb
    s_waitcnt lgkmcnt(0)
    v_mov_b32 v4, 60936
    s_mov_b64 exec, 1
    ds_add_u32 v4, v171
    s_mov_b64 exec, -1
    v_mov_b32 v44, 0
    v_mov_b32 v45, 0
    v_mov_b32 v46, 0
    v_mov_b32 v47, 0
    v_mov_b32 v48, 0
    v_mov_b32 v49, 0
    v_mov_b32 v50, 0
    v_mov_b32 v51, 0
    v_mov_b32 v100, 0
    v_mov_b32 v101, 0
    v_mov_b32 v102, 0
    v_mov_b32 v103, 0
    v_mov_b32 v104, 0
    v_mov_b32 v105, 0
    v_mov_b32 v106, 0
    v_mov_b32 v107, 0
    s_mov_b32 s54, 0
    s_waitcnt vmcnt(0) lgkmcnt(0)
    ds_read_b128 v[28:31], v148
    ds_read_b128 v[32:35], v149
    ds_read_b128 v[36:39], v150
    ds_read_b128 v[40:43], v151
    ds_read_b32 v18, v157
    ds_read_u16 v19, v158
    v_add_u32 v161, v153, v165
    v_add_u32 v162, v155, v165
    ds_read_b32 v20, v161
    ds_read_b32 v21, v162
    ds_read_b32 v24, v161 offset:128
    ds_read_b32 v25, v162 offset:128
    ds_read_u16 v140, v156 offset:0
    ds_read_u16 v142, v156 offset:16
    ds_read_u16 v144, v156 offset:64
    ds_read_u16 v146, v156 offset:80
    s_waitcnt lgkmcnt(0)
    s_add_u32 m0, s57, 0
    s_nop 0
    buffer_load_dwordx4 v[140:141], s[48:51], 0 idxen offen sc1 lds
    s_add_u32 m0, s57, 1024
    s_nop 0
    buffer_load_dwordx4 v[142:143], s[48:51], 0 idxen offen sc1 lds
    s_add_u32 m0, s57, 2048
    s_nop 0
    buffer_load_dwordx4 v[144:145], s[48:51], 0 idxen offen sc1 lds
    s_add_u32 m0, s57, 3072
    s_nop 0
    buffer_load_dwordx4 v[146:147], s[48:51], 0 idxen offen sc1 lds
    v_mfma_f32_32x32x16_bf16 v[52:67], v[16:19], v[20:23], 0
    v_mfma_f32_32x32x16_bf16 v[52:67], v[28:31], v[8:11], v[52:67]
    v_mfma_f32_32x32x16_bf16 v[52:67], v[32:35], v[12:15], v[52:67]
    v_add_u32 v156, 128, v156
    v_add_u32 v157, 128, v157
    v_add_u32 v158, 64, v158
    s_nop 7
    s_nop 3
    s_lshl_b32 s4, s3, 2
    s_add_u32 s5, s4, 60800
    v_mov_b32 v108, s5
    s_xor_b32 s4, s4, 16
    s_add_u32 s5, s4, 60800
    v_mov_b32 v109, s5
    v_mov_b32 v111, 0
    ds_write_b32 v108, v111
L_loop:
    v_mfma_f32_32x32x16_bf16 v[228:243], v[44:47], v[100:103], v[228:243]
    v_exp_f32 v84, v52
    v_exp_f32 v85, v53
    v_exp_f32 v86, v54
    v_exp_f32 v87, v55
    v_mfma_f32_32x32x16_bf16 v[228:243], v[48:51], v[104:107], v[228:243]
    v_exp_f32 v88, v56
    v_exp_f32 v89, v57
    v_exp_f32 v90, v58
    v_exp_f32 v91, v59
    v_add_u32 v163, v152, v160
    v_add_u32 v164, v154, v160
    v_exp_f32 v92, v60
    v_exp_f32 v93, v61
    v_exp_f32 v94, v62
    v_exp_f32 v95, v63
    ds_read_b128 v[44:47], v163
    ds_read_b128 v[48:51], v164 offset:32
    v_add_u32 v159, 32, v159
    v_add_u32 v160, 64, v160
    ds_read2_b64 v[152:155], v159 offset0:0 offset1:2
    v_exp_f32 v96, v64
    v_exp_f32 v97, v65
    ds_read_u16 v140, v156 offset:0
    ds_read_u16 v142, v156 offset:16
    ds_read_u16 v144, v156 offset:64
    ds_read_u16 v146, v156 offset:80
    ds_read_b32 v110, v109
    v_exp_f32 v98, v66
    v_exp_f32 v99, v67
    v_pk_add_f32 v[84:85], v[84:85], s[52:53]
    v_pk_add_f32 v[86:87], v[86:87], s[52:53]
    v_pk_add_f32 v[88:89], v[88:89], s[52:53]
    v_pk_add_f32 v[90:91], v[90:91], s[52:53]
    v_pk_add_f32 v[92:93], v[92:93], s[52:53]
    v_pk_add_f32 v[94:95], v[94:95], s[52:53]
    v_pk_add_f32 v[96:97], v[96:97], s[52:53]
    v_pk_add_f32 v[98:99], v[98:99], s[52:53]
    v_mfma_f32_32x32x16_bf16 v[68:83], v[16:19], v[24:27], 0
    v_rcp_f32 v84, v84
    v_rcp_f32 v85, v85
    v_rcp_f32 v86, v86
    v_rcp_f32 v87, v87
    v_mfma_f32_32x32x16_bf16 v[68:83], v[36:39], v[8:11], v[68:83]
    v_rcp_f32 v88, v88
    v_rcp_f32 v89, v89
    v_rcp_f32 v90, v90
    v_rcp_f32 v91, v91
    v_mfma_f32_32x32x16_bf16 v[68:83], v[40:43], v[12:15], v[68:83]
    v_rcp_f32 v92, v92
    v_rcp_f32 v93, v93
    v_rcp_f32 v94, v94
    v_rcp_f32 v95, v95
    v_rcp_f32 v96, v96
    v_rcp_f32 v97, v97
    v_rcp_f32 v98, v98
    v_rcp_f32 v99, v99
    v_pk_mul_f32 v[84:85], v[84:85], v[52:53]
    v_pk_mul_f32 v[86:87], v[86:87], v[54:55]
    v_pk_mul_f32 v[88:89], v[88:89], v[56:57]
    v_pk_mul_f32 v[90:91], v[90:91], v[58:59]
    v_pk_mul_f32 v[92:93], v[92:93], v[60:61]
    v_pk_mul_f32 v[94:95], v[94:95], v[62:63]
    v_pk_mul_f32 v[96:97], v[96:97], v[64:65]
    v_pk_mul_f32 v[98:99], v[98:99], v[66:67]
    v_cvt_pk_bf16_f32 v100, v84, v85
    v_cvt_pk_bf16_f32 v101, v86, v87
    v_cvt_pk_bf16_f32 v102, v88, v89
    v_cvt_pk_bf16_f32 v103, v90, v91
    v_cvt_pk_bf16_f32 v104, v92, v93
    v_cvt_pk_bf16_f32 v105, v94, v95
    v_cvt_pk_bf16_f32 v106, v96, v97
    v_cvt_pk_bf16_f32 v107, v98, v99
    s_waitcnt vmcnt(0) lgkmcnt(0)
    ds_read_b128 v[28:31], v148
    ds_read_b128 v[32:35], v149
    ds_read_b128 v[36:39], v150
    ds_read_b128 v[40:43], v151
    ds_read_b32 v18, v157
    ds_read_u16 v19, v158
    v_add_u32 v161, v153, v165
    v_add_u32 v162, v155, v165
    ds_read_b32 v20, v161
    ds_read_b32 v21, v162
    ds_read_b32 v24, v161 offset:128
    ds_read_b32 v25, v162 offset:128
    v_exp_f32 v84, v68
    v_exp_f32 v85, v69
    v_mfma_f32_32x32x16_bf16 v[212:227], v[44:47], v[100:103], v[212:227]
    v_exp_f32 v86, v70
    v_exp_f32 v87, v71
    v_exp_f32 v88, v72
    v_exp_f32 v89, v73
    v_mfma_f32_32x32x16_bf16 v[212:227], v[48:51], v[104:107], v[212:227]
    v_exp_f32 v90, v74
    v_exp_f32 v91, v75
    v_exp_f32 v92, v76
    v_exp_f32 v93, v77
    v_exp_f32 v94, v78
    v_exp_f32 v95, v79
    v_exp_f32 v96, v80
    v_exp_f32 v97, v81
    v_exp_f32 v98, v82
    v_exp_f32 v99, v83
    v_pk_add_f32 v[84:85], v[84:85], s[52:53]
    v_pk_add_f32 v[86:87], v[86:87], s[52:53]
    v_pk_add_f32 v[88:89], v[88:89], s[52:53]
    v_pk_add_f32 v[90:91], v[90:91], s[52:53]
    v_pk_add_f32 v[92:93], v[92:93], s[52:53]
    v_pk_add_f32 v[94:95], v[94:95], s[52:53]
    v_pk_add_f32 v[96:97], v[96:97], s[52:53]
    v_pk_add_f32 v[98:99], v[98:99], s[52:53]
    s_waitcnt lgkmcnt(0)
    v_mfma_f32_32x32x16_bf16 v[52:67], v[16:19], v[20:23], 0
    v_rcp_f32 v84, v84
    v_rcp_f32 v85, v85
    s_add_u32 m0, s57, 0
    s_nop 0
    buffer_load_dwordx4 v[140:141], s[48:51], 0 idxen offen sc1 lds
    v_rcp_f32 v86, v86
    v_rcp_f32 v87, v87
    v_mfma_f32_32x32x16_bf16 v[52:67], v[28:31], v[8:11], v[52:67]
    v_rcp_f32 v88, v88
    v_rcp_f32 v89, v89
    s_add_u32 m0, s57, 1024
    s_nop 0
    buffer_load_dwordx4 v[142:143], s[48:51], 0 idxen offen sc1 lds
    v_rcp_f32 v90, v90
    v_rcp_f32 v91, v91
    v_mfma_f32_32x32x16_bf16 v[52:67], v[32:35], v[12:15], v[52:67]
    v_rcp_f32 v92, v92
    v_rcp_f32 v93, v93
    s_add_u32 m0, s57, 2048
    s_nop 0
    buffer_load_dwordx4 v[144:145], s[48:51], 0 idxen offen sc1 lds
    v_rcp_f32 v94, v94
    v_rcp_f32 v95, v95
    s_add_u32 m0, s57, 3072
    s_nop 0
    buffer_load_dwordx4 v[146:147], s[48:51], 0 idxen offen sc1 lds
    v_rcp_f32 v96, v96
    v_rcp_f32 v97, v97
    v_rcp_f32 v98, v98
    v_rcp_f32 v99, v99
    v_add_u32 v156, 128, v156
    v_add_u32 v157, 128, v157
    v_add_u32 v158, 64, v158
    v_pk_mul_f32 v[84:85], v[84:85], v[68:69]
    v_pk_mul_f32 v[86:87], v[86:87], v[70:71]
    v_pk_mul_f32 v[88:89], v[88:89], v[72:73]
    v_pk_mul_f32 v[90:91], v[90:91], v[74:75]
    v_pk_mul_f32 v[92:93], v[92:93], v[76:77]
    v_pk_mul_f32 v[94:95], v[94:95], v[78:79]
    v_pk_mul_f32 v[96:97], v[96:97], v[80:81]
    v_pk_mul_f32 v[98:99], v[98:99], v[82:83]
    v_cvt_pk_bf16_f32 v100, v84, v85
    v_cvt_pk_bf16_f32 v101, v86, v87
    v_cvt_pk_bf16_f32 v102, v88, v89
    v_cvt_pk_bf16_f32 v103, v90, v91
    v_cvt_pk_bf16_f32 v104, v92, v93
    v_cvt_pk_bf16_f32 v105, v94, v95
    v_cvt_pk_bf16_f32 v106, v96, v97
    v_cvt_pk_bf16_f32 v107, v98, v99
    s_add_u32 s54, s54, 1
    v_mov_b32 v111, s54
    v_readfirstlane_b32 s4, v110
    ds_write_b32 v108, v111
    s_cmp_le_u32 s54, s4
    s_cbranch_scc1 L_phi
    s_setprio 0
    s_branch L_pdone
L_phi:
    s_setprio 1
L_pdone:
    s_cmp_lt_u32 s54, s55
    s_cbranch_scc1 L_loop
    s_nop 1
    v_mfma_f32_32x32x16_bf16 v[228:243], v[44:47], v[100:103], v[228:243]
    v_mfma_f32_32x32x16_bf16 v[228:243], v[48:51], v[104:107], v[228:243]
    s_waitcnt vmcnt(0)
    s_setprio 0
    v_mov_b32 v111, 0x7fffffff
    ds_write_b32 v108, v111
    s_cmp_eq_u32 s58, 0
    s_cbranch_scc1 L_epi
    s_add_u32 s60, s60, 1
    s_cmp_lt_u32 s60, 4
    s_cbranch_scc1 L_nextb
    s_mov_b32 s60, 0
    s_add_u32 s59, s59, 1
    s_lshl_b32 s4, s59, 5
    s_cmp_ge_u32 s4, s61
    s_cbranch_scc1 L_epi
L_nextb:
    s_waitcnt vmcnt(0) lgkmcnt(0)
    s_barrier
    v_mov_b32 v4, 10000
    v_mov_b32 v5, 10000
    v_lshlrev_b32 v6, 3, v0
    v_add_u32 v6, 145104, v6
    ds_write_b64 v6, v[4:5] offset:0
    ds_write_b64 v6, v[4:5] offset:4096
    ds_write_b64 v6, v[4:5] offset:8192
    v_lshlrev_b32 v6, 2, v0
    v_add_u32 v6, 157392, v6
    v_cmp_gt_u32 vcc, 64, v0
    s_and_saveexec_b64 s[4:5], vcc
    ds_write_b32 v6, v4
    s_mov_b64 exec, s[4:5]
    v_lshlrev_b32 v4, 2, v1
    v_mov_b32 v5, 0
    ds_write_b32 v4, v5 offset:60416
    s_waitcnt lgkmcnt(0)
    s_barrier
    s_branch L_batch
L_epi:
    s_cmp_ge_u32 s3, 4
    s_cbranch_scc1 L_norow
    v_mov_b32 v4, 60944
    ds_read_b128 v[44:47], v4
    ds_read_b128 v[48:51], v4 offset:16
    s_cmp_eq_u32 s40, 0
    s_cbranch_scc1 L_rowE
    s_waitcnt lgkmcnt(0)
    v_mov_b32 v44, 0
    v_mov_b32 v45, 5
    v_mov_b32 v46, 10
    v_mov_b32 v47, 15
    v_mov_b32 v48, 20
    v_mov_b32 v49, 25
    v_mov_b32 v50, 30
    v_mov_b32 v51, 35
L_rowE:
    s_waitcnt lgkmcnt(0)
    v_mov_b32 v52, v1
    v_mov_b32 v53, 0x10000
    v_mov_b32 v139, 0
    v_cmp_le_u32 vcc, v45, v1
    v_sub_u32 v136, v1, v45
    v_add_u32 v136, 8, v136
    v_sub_u32 v137, v1, v44
    v_cndmask_b32 v52, v52, v136, vcc
    v_add_u32 v138, 0, v137
    v_cndmask_b32 v53, v53, v138, vcc
    v_cndmask_b32 v139, v139, v137, vcc
    v_cmp_le_u32 vcc, v46, v1
    v_sub_u32 v136, v1, v46
    v_add_u32 v136, 16, v136
    v_sub_u32 v137, v1, v45
    v_cndmask_b32 v52, v52, v136, vcc
    v_add_u32 v138, 8, v137
    v_cndmask_b32 v53, v53, v138, vcc
    v_cndmask_b32 v139, v139, v137, vcc
    v_cmp_le_u32 vcc, v47, v1
    v_sub_u32 v136, v1, v47
    v_add_u32 v136, 24, v136
    v_sub_u32 v137, v1, v46
    v_cndmask_b32 v52, v52, v136, vcc
    v_add_u32 v138, 16, v137
    v_cndmask_b32 v53, v53, v138, vcc
    v_cndmask_b32 v139, v139, v137, vcc
    v_cmp_le_u32 vcc, v48, v1
    v_sub_u32 v136, v1, v48
    v_add_u32 v136, 32, v136
    v_sub_u32 v137, v1, v47
    v_cndmask_b32 v52, v52, v136, vcc
    v_add_u32 v138, 24, v137
    v_cndmask_b32 v53, v53, v138, vcc
    v_cndmask_b32 v139, v139, v137, vcc
    v_cmp_le_u32 vcc, v49, v1
    v_sub_u32 v136, v1, v49
    v_add_u32 v136, 40, v136
    v_sub_u32 v137, v1, v48
    v_cndmask_b32 v52, v52, v136, vcc
    v_add_u32 v138, 32, v137
    v_cndmask_b32 v53, v53, v138, vcc
    v_cndmask_b32 v139, v139, v137, vcc
    v_cmp_le_u32 vcc, v50, v1
    v_sub_u32 v136, v1, v50
    v_add_u32 v136, 48, v136
    v_sub_u32 v137, v1, v49
    v_cndmask_b32 v52, v52, v136, vcc
    v_add_u32 v138, 40, v137
    v_cndmask_b32 v53, v53, v138, vcc
    v_cndmask_b32 v139, v139, v137, vcc
    v_cmp_le_u32 vcc, v51, v1
    v_sub_u32 v136, v1, v51
    v_add_u32 v136, 56, v136
    v_sub_u32 v137, v1, v50
    v_cndmask_b32 v52, v52, v136, vcc
    v_add_u32 v138, 48, v137
    v_cndmask_b32 v53, v53, v138, vcc
    v_cndmask_b32 v139, v139, v137, vcc
    v_cmp_lt_u32 vcc, 7, v139
    v_mov_b32 v136, 0x10000
    s_nop 0
    v_cndmask_b32 v53, v53, v136, vcc
    v_and_b32 v137, 7, v52
    v_cmp_ne_u32 vcc, 0, v137
    s_nop 1
    v_cndmask_b32 v53, v53, v136, vcc
    s_cmp_eq_u32 s40, 0
    s_cselect_b32 s4, 0, 0x10000
    v_or_b32 v53, s4, v53
    v_lshlrev_b32 v4, 3, v1
    ds_write_b64 v4, v[52:53] offset:60992
L_norow:
    s_mul_i32 s4, s3, 2176
    v_mul_u32_u24 v4, 272, v3
    v_lshlrev_b32 v6, 2, v2
    v_add3_u32 v4, v4, v6, s4
    s_mul_i32 s4, s3, 3072
    v_mul_u32_u24 v5, 384, v3
    v_add3_u32 v5, v5, v6, s4
    s_nop 3
    v_mul_f32 v29, v213, v166
    v_fmac_f32 v29, v229, v167
    v_mul_f32 v30, v214, v166
    v_fmac_f32 v30, v230, v167
    v_mul_f32 v31, v215, v166
    v_fmac_f32 v31, v231, v167
    v_mul_f32 v32, v217, v166
    v_fmac_f32 v32, v233, v167
    v_mul_f32 v33, v218, v166
    v_fmac_f32 v33, v234, v167
    v_mul_f32 v34, v219, v166
    v_fmac_f32 v34, v235, v167
    v_mul_f32 v35, v221, v166
    v_fmac_f32 v35, v237, v167
    v_mul_f32 v36, v222, v166
    v_fmac_f32 v36, v238, v167
    v_mul_f32 v37, v223, v166
    v_fmac_f32 v37, v239, v167
    v_mul_f32 v38, v225, v166
    v_fmac_f32 v38, v241, v167
    v_mul_f32 v39, v226, v166
    v_fmac_f32 v39, v242, v167
    v_mul_f32 v40, v227, v166
    v_fmac_f32 v40, v243, v167
    s_cmp_ge_u32 s3, 4
    s_cbranch_scc1 L_nd4
    s_lshr_b32 s5, s3, 1
    s_lshl_b32 s5, s5, 5
    v_add_u32 v7, s5, v2
    s_branch L_nd5
L_nd4:
    v_subrev_u32 v7, 256, v0
    v_lshrrev_b32 v7, 1, v7
    v_mul_u32_u24 v7, 171, v7
    v_lshrrev_b32 v7, 9, v7
L_nd5:
    v_lshlrev_b32 v8, 3, v7
    s_cmp_eq_u32 s58, 0
    s_cbranch_scc1 L_fastb1
    s_waitcnt lgkmcnt(0)
    s_barrier
    s_branch L_b1done
L_fastb1:
    v_mov_b32 v9, 60936
    s_mov_b32 s6, 0x100000
L_bspin:
    ds_read_b32 v10, v9
    s_waitcnt lgkmcnt(0)
    v_readfirstlane_b32 s4, v10
    s_sub_u32 s6, s6, 1
    s_cmp_ge_u32 s4, 8
    s_cbranch_scc1 L_b1done
    s_cmp_lg_u32 s6, 0
    s_cbranch_scc1 L_bspin
L_b1done:
    ds_write_b32 v4, v212 offset:0
    ds_write_b32 v4, v228 offset:128
    ds_write_b32 v5, v29 offset:17408
    ds_write_b32 v5, v30 offset:17536
    ds_write_b32 v5, v31 offset:17664
    ds_write_b32 v4, v216 offset:544
    ds_write_b32 v4, v232 offset:672
    ds_write_b32 v5, v32 offset:18176
    ds_write_b32 v5, v33 offset:18304
    ds_write_b32 v5, v34 offset:18432
    ds_write_b32 v4, v220 offset:1088
    ds_write_b32 v4, v236 offset:1216
    ds_write_b32 v5, v35 offset:18944
    ds_write_b32 v5, v36 offset:19072
    ds_write_b32 v5, v37 offset:19200
    ds_write_b32 v4, v224 offset:1632
    ds_write_b32 v4, v240 offset:1760
    ds_write_b32 v5, v38 offset:19712
    ds_write_b32 v5, v39 offset:19840
    ds_write_b32 v5, v40 offset:19968
    s_cmp_ge_u32 s3, 4
    s_cbranch_scc1 L_epos0
    v_mov_b32 v4, v7
    v_lshlrev_b32 v6, 5, v3
    s_waitcnt lgkmcnt(0)
    s_barrier
    ds_read_b64 v[10:11], v8 offset:60992
    s_waitcnt lgkmcnt(0)
    v_mul_u32_u24 v5, 272, v10
    v_add_u32 v5, v5, v6
    v_mul_u32_u24 v7, 272, v11
    v_add_u32 v7, v7, v6
    ds_read_b128 v[44:47], v5 offset:0
    ds_read_b128 v[48:51], v5 offset:16
    ds_read_b128 v[84:87], v7 offset:0
    ds_read_b128 v[88:91], v7 offset:16
    ds_read_b128 v[52:55], v5 offset:64
    ds_read_b128 v[56:59], v5 offset:80
    ds_read_b128 v[92:95], v7 offset:64
    ds_read_b128 v[96:99], v7 offset:80
    ds_read_b128 v[60:63], v5 offset:128
    ds_read_b128 v[64:67], v5 offset:144
    ds_read_b128 v[100:103], v7 offset:128
    ds_read_b128 v[104:107], v7 offset:144
    ds_read_b128 v[68:71], v5 offset:192
    ds_read_b128 v[72:75], v5 offset:208
    ds_read_b128 v[108:111], v7 offset:192
    ds_read_b128 v[112:115], v7 offset:208
    s_lshr_b32 s4, s3, 1
    v_lshrrev_b32 v6, 1, v2
    v_and_b32 v6, 7, v6
    s_and_b32 s6, s3, 1
    s_lshl_b32 s7, s6, 2
    v_xor_b32 v6, s7, v6
    v_lshlrev_b32 v6, 4, v6
    v_lshlrev_b32 v7, 7, v4
    v_lshlrev_b32 v136, 3, v3
    v_add_u32 v7, v7, v136
    v_add_u32 v7, 139984, v7
    v_xor_b32 v136, 0, v6
    v_add_u32 v136, v136, v7
    ds_read_b64 v[76:77], v136
    v_xor_b32 v136, 16, v6
    v_add_u32 v136, v136, v7
    ds_read_b64 v[78:79], v136
    v_xor_b32 v136, 32, v6
    v_add_u32 v136, v136, v7
    ds_read_b64 v[80:81], v136
    v_xor_b32 v136, 48, v6
    v_add_u32 v136, v136, v7
    ds_read_b64 v[82:83], v136
    s_mov_b32 s96, 0xbf317218
    s_mov_b32 s97, 0xbf317218
    s_waitcnt lgkmcnt(15)
    v_pk_add_f32 v[44:45], v[44:45], v[84:85]
    v_pk_add_f32 v[46:47], v[46:47], v[86:87]
    v_pk_add_f32 v[48:49], v[48:49], v[88:89]
    v_pk_add_f32 v[50:51], v[50:51], v[90:91]
    v_pk_mul_f32 v[44:45], v[44:45], s[96:97]
    v_pk_mul_f32 v[46:47], v[46:47], s[96:97]
    v_pk_mul_f32 v[48:49], v[48:49], s[96:97]
    v_pk_mul_f32 v[50:51], v[50:51], s[96:97]
    v_cvt_pk_bf16_f32 v28, v44, v45
    v_cvt_pk_bf16_f32 v29, v46, v47
    v_cvt_pk_bf16_f32 v30, v48, v49
    v_cvt_pk_bf16_f32 v31, v50, v51
    s_nop 1
    v_mfma_f32_32x32x16_bf16 v[172:187], v[188:191], v[28:31], v[172:187]
    s_waitcnt lgkmcnt(12)
    v_pk_add_f32 v[52:53], v[52:53], v[92:93]
    v_pk_add_f32 v[54:55], v[54:55], v[94:95]
    v_pk_add_f32 v[56:57], v[56:57], v[96:97]
    v_pk_add_f32 v[58:59], v[58:59], v[98:99]
    v_pk_mul_f32 v[52:53], v[52:53], s[96:97]
    v_pk_mul_f32 v[54:55], v[54:55], s[96:97]
    v_pk_mul_f32 v[56:57], v[56:57], s[96:97]
    v_pk_mul_f32 v[58:59], v[58:59], s[96:97]
    v_cvt_pk_bf16_f32 v32, v52, v53
    v_cvt_pk_bf16_f32 v33, v54, v55
    v_cvt_pk_bf16_f32 v34, v56, v57
    v_cvt_pk_bf16_f32 v35, v58, v59
    s_nop 1
    v_mfma_f32_32x32x16_bf16 v[172:187], v[192:195], v[32:35], v[172:187]
    s_waitcnt lgkmcnt(8)
    v_pk_add_f32 v[60:61], v[60:61], v[100:101]
    v_pk_add_f32 v[62:63], v[62:63], v[102:103]
    v_pk_add_f32 v[64:65], v[64:65], v[104:105]
    v_pk_add_f32 v[66:67], v[66:67], v[106:107]
    v_pk_mul_f32 v[60:61], v[60:61], s[96:97]
    v_pk_mul_f32 v[62:63], v[62:63], s[96:97]
    v_pk_mul_f32 v[64:65], v[64:65], s[96:97]
    v_pk_mul_f32 v[66:67], v[66:67], s[96:97]
    v_cvt_pk_bf16_f32 v36, v60, v61
    v_cvt_pk_bf16_f32 v37, v62, v63
    v_cvt_pk_bf16_f32 v38, v64, v65
    v_cvt_pk_bf16_f32 v39, v66, v67
    s_nop 1
    v_mfma_f32_32x32x16_bf16 v[172:187], v[196:199], v[36:39], v[172:187]
    s_waitcnt lgkmcnt(4)
    v_pk_add_f32 v[68:69], v[68:69], v[108:109]
    v_pk_add_f32 v[70:71], v[70:71], v[110:111]
    v_pk_add_f32 v[72:73], v[72:73], v[112:113]
    v_pk_add_f32 v[74:75], v[74:75], v[114:115]
    v_pk_mul_f32 v[68:69], v[68:69], s[96:97]
    v_pk_mul_f32 v[70:71], v[70:71], s[96:97]
    v_pk_mul_f32 v[72:73], v[72:73], s[96:97]
    v_pk_mul_f32 v[74:75], v[74:75], s[96:97]
    v_cvt_pk_bf16_f32 v40, v68, v69
    v_cvt_pk_bf16_f32 v41, v70, v71
    v_cvt_pk_bf16_f32 v42, v72, v73
    v_cvt_pk_bf16_f32 v43, v74, v75
    s_nop 1
    v_mfma_f32_32x32x16_bf16 v[172:187], v[200:203], v[40:43], v[172:187]
    s_mul_i32 s5, s2, 40
    v_add_u32 v4, s5, v4
    v_lshlrev_b32 v4, 7, v4
    s_lshl_b32 s6, s6, 6
    v_lshlrev_b32 v5, 4, v3
    v_add3_u32 v4, v4, v5, s6
    s_mov_b32 s5, 0xbfb8aa3b
    s_mov_b32 s7, 0xffff0000
    s_waitcnt lgkmcnt(0)
    v_lshlrev_b32 v60, 16, v76
    v_and_b32 v61, s7, v76
    v_lshlrev_b32 v62, 16, v77
    v_and_b32 v63, s7, v77
    v_lshlrev_b32 v64, 16, v78
    v_and_b32 v65, s7, v78
    v_lshlrev_b32 v66, 16, v79
    v_and_b32 v67, s7, v79
    v_lshlrev_b32 v68, 16, v80
    v_and_b32 v69, s7, v80
    v_lshlrev_b32 v70, 16, v81
    v_and_b32 v71, s7, v81
    v_lshlrev_b32 v72, 16, v82
    v_and_b32 v73, s7, v82
    v_lshlrev_b32 v74, 16, v83
    v_and_b32 v75, s7, v83
    v_mul_f32 v44, s5, v172
    v_mul_f32 v45, s5, v173
    v_mul_f32 v46, s5, v174
    v_mul_f32 v47, s5, v175
    v_mul_f32 v48, s5, v176
    v_mul_f32 v49, s5, v177
    v_mul_f32 v50, s5, v178
    v_mul_f32 v51, s5, v179
    v_mul_f32 v52, s5, v180
    v_mul_f32 v53, s5, v181
    v_mul_f32 v54, s5, v182
    v_mul_f32 v55, s5, v183
    v_mul_f32 v56, s5, v184
    v_mul_f32 v57, s5, v185
    v_mul_f32 v58, s5, v186
    v_mul_f32 v59, s5, v187
    v_exp_f32 v44, v44
    v_exp_f32 v45, v45
    v_exp_f32 v46, v46
    v_exp_f32 v47, v47
    v_exp_f32 v48, v48
    v_exp_f32 v49, v49
    v_exp_f32 v50, v50
    v_exp_f32 v51, v51
    v_exp_f32 v52, v52
    v_exp_f32 v53, v53
    v_exp_f32 v54, v54
    v_exp_f32 v55, v55
    v_exp_f32 v56, v56
    v_exp_f32 v57, v57
    v_exp_f32 v58, v58
    v_exp_f32 v59, v59
    v_pk_add_f32 v[44:45], v[44:45], s[52:53]
    v_pk_add_f32 v[46:47], v[46:47], s[52:53]
    v_pk_add_f32 v[48:49], v[48:49], s[52:53]
    v_pk_add_f32 v[50:51], v[50:51], s[52:53]
    v_pk_add_f32 v[52:53], v[52:53], s[52:53]
    v_pk_add_f32 v[54:55], v[54:55], s[52:53]
    v_pk_add_f32 v[56:57], v[56:57], s[52:53]
    v_pk_add_f32 v[58:59], v[58:59], s[52:53]
    v_rcp_f32 v44, v44
    v_rcp_f32 v45, v45
    v_rcp_f32 v46, v46
    v_rcp_f32 v47, v47
    v_rcp_f32 v48, v48
    v_rcp_f32 v49, v49
    v_rcp_f32 v50, v50
    v_rcp_f32 v51, v51
    v_rcp_f32 v52, v52
    v_rcp_f32 v53, v53
    v_rcp_f32 v54, v54
    v_rcp_f32 v55, v55
    v_rcp_f32 v56, v56
    v_rcp_f32 v57, v57
    v_rcp_f32 v58, v58
    v_rcp_f32 v59, v59
    s_nop 0
    v_pk_fma_f32 v[60:61], v[172:173], v[44:45], v[60:61]
    v_pk_fma_f32 v[62:63], v[174:175], v[46:47], v[62:63]
    v_pk_fma_f32 v[64:65], v[176:177], v[48:49], v[64:65]
    v_pk_fma_f32 v[66:67], v[178:179], v[50:51], v[66:67]
    v_pk_fma_f32 v[68:69], v[180:181], v[52:53], v[68:69]
    v_pk_fma_f32 v[70:71], v[182:183], v[54:55], v[70:71]
    v_pk_fma_f32 v[72:73], v[184:185], v[56:57], v[72:73]
    v_pk_fma_f32 v[74:75], v[186:187], v[58:59], v[74:75]
    v_cvt_pk_bf16_f32 v28, v60, v61
    v_cvt_pk_bf16_f32 v29, v62, v63
    v_cvt_pk_bf16_f32 v30, v64, v65
    v_cvt_pk_bf16_f32 v31, v66, v67
    v_cvt_pk_bf16_f32 v32, v68, v69
    v_cvt_pk_bf16_f32 v33, v70, v71
    v_cvt_pk_bf16_f32 v34, v72, v73
    v_cvt_pk_bf16_f32 v35, v74, v75
    s_nop 1
    v_permlane32_swap_b32 v28, v30
    v_permlane32_swap_b32 v29, v31
    v_permlane32_swap_b32 v32, v34
    v_permlane32_swap_b32 v33, v35
    s_cmp_eq_u32 s4, 0
    s_cselect_b32 s4, 32, 8
    v_cmp_gt_u32 vcc, s4, v2
    s_and_saveexec_b64 s[96:97], vcc
    global_store_dwordx4 v4, v[28:31], s[24:25] sc1
    global_store_dwordx4 v4, v[32:35], s[24:25] offset:32 sc1
    s_endpgm
L_epos0:
    v_subrev_u32 v4, 256, v0
    v_lshrrev_b32 v5, 1, v4
    v_mul_u32_u24 v6, 3, v7
    v_sub_u32 v6, v5, v6
    v_lshlrev_b32 v6, 7, v6
    v_and_b32 v8, 1, v4
    v_lshlrev_b32 v8, 6, v8
    v_add_u32 v8, v6, v8
    v_lshlrev_b32 v9, 3, v7
    s_waitcnt lgkmcnt(0)
    s_barrier
    ds_read_b64 v[10:11], v9 offset:60992
    s_waitcnt lgkmcnt(0)
    v_mul_u32_u24 v9, 384, v10
    v_add_u32 v9, v9, v8
    v_mul_u32_u24 v10, 384, v11
    v_add_u32 v10, v10, v8
    ds_read_b128 v[28:31], v9 offset:17408
    ds_read_b128 v[32:35], v9 offset:17424
    ds_read_b128 v[36:39], v9 offset:17440
    ds_read_b128 v[40:43], v9 offset:17456
    ds_read_b128 v[44:47], v10 offset:17408
    ds_read_b128 v[48:51], v10 offset:17424
    ds_read_b128 v[52:55], v10 offset:17440
    ds_read_b128 v[56:59], v10 offset:17456
    s_waitcnt lgkmcnt(0)
    v_add_f32 v28, v28, v44
    v_add_f32 v29, v29, v45
    v_add_f32 v30, v30, v46
    v_add_f32 v31, v31, v47
    v_add_f32 v32, v32, v48
    v_add_f32 v33, v33, v49
    v_add_f32 v34, v34, v50
    v_add_f32 v35, v35, v51
    v_add_f32 v36, v36, v52
    v_add_f32 v37, v37, v53
    v_add_f32 v38, v38, v54
    v_add_f32 v39, v39, v55
    v_add_f32 v40, v40, v56
    v_add_f32 v41, v41, v57
    v_add_f32 v42, v42, v58
    v_add_f32 v43, v43, v59
    v_add_f32 v28, v28, v32
    v_add_f32 v29, v29, v33
    v_add_f32 v30, v30, v34
    v_add_f32 v31, v31, v35
    v_add_f32 v28, v28, v36
    v_add_f32 v29, v29, v37
    v_add_f32 v30, v30, v38
    v_add_f32 v31, v31, v39
    v_add_f32 v28, v28, v40
    v_add_f32 v29, v29, v41
    v_add_f32 v30, v30, v42
    v_add_f32 v31, v31, v43
    v_add_f32 v28, v28, v29
    v_add_f32 v30, v30, v31
    v_add_f32 v28, v28, v30
    s_nop 1
    v_add_f32_dpp v28, v28, v28 quad_perm:[1,0,3,2] row_mask:0xf bank_mask:0xf
    v_add_f32 v28, v28, v170
    v_cvt_pk_bf16_f32 v28, v28, v28
    s_mul_i32 s4, s2, 240
    s_add_u32 s4, s4, 1280000
    v_lshlrev_b32 v5, 1, v5
    v_add_u32 v5, s4, v5
    v_and_b32 v6, 1, v4
    v_cmp_gt_u32 vcc, 240, v4
    s_mov_b64 s[96:97], vcc
    v_cmp_eq_u32 vcc, 0, v6
    s_and_b64 vcc, vcc, s[96:97]
    s_and_saveexec_b64 s[96:97], vcc
    global_store_short v5, v28, s[24:25] sc1
L_end:
    s_endpgm

.section .rodata,"a"
.p2align 6
.amdhsa_kernel gather_scatter__cheap_equivariant_egnn__graph_kernel
  .amdhsa_next_free_vgpr 256
  .amdhsa_next_free_sgpr 102
  .amdhsa_accum_offset 256
  .amdhsa_group_segment_fixed_size 0
  .amdhsa_kernarg_size 88
  .amdhsa_user_sgpr_count 2
  .amdhsa_user_sgpr_kernarg_segment_ptr 1
  .amdhsa_system_sgpr_workgroup_id_x 1
.end_amdhsa_kernel
```
